```python
import torch

def _softmax(x, axis=-1):
    return torch.softmax(x, dim=axis)
def _gelu(x):
    return torch.nn.functional.gelu(x, approximate="tanh")
def _silu(x):
    return torch.nn.functional.silu(x)
def _sigmoid(x):
    return torch.sigmoid(x)
def _layernorm(x, axis=-1, eps=1e-5):
    m = x.mean(dim=axis, keepdim=True)
    v = x.var(dim=axis, keepdim=True, unbiased=False)
    return (x - m) / torch.sqrt(v + eps)
def _scatter_add(tgt, idx, src, axis=0):
    return tgt.clone().index_add_(axis, idx, src)
def _segment_sum(src, seg, n):
    out = torch.zeros((n,) + src.shape[1:], dtype=src.dtype)
    return out.index_add_(0, seg, src)
def _pad(x, pw):
    flat = tuple(v for pair in reversed(pw) for v in pair)
    return torch.nn.functional.pad(x, flat)

kernel_name = 'sequential_preLN__gqa_block_cached__swiglu_ffn__decode'

def setup_inputs():

    _w = (lambda a: (lambda t: t.to(torch.bfloat16) if t.is_floating_point() else t)(torch.as_tensor(a)))
    def _A_setup():
        B, Sq, D = 2, 1, 512
        Hq, Hkv, Sk, Dh = 32, 8, 16384, 128
        assert Hq % Hkv == 0, (Hq, Hkv)
        return {
            "x": _w((lambda *s: torch.randn(*s, dtype=torch.bfloat16) * 0.05)(B, Sq, D)),
            "k_cache": _w((lambda *s: torch.randn(*s, dtype=torch.bfloat16) * 3.2)(B, Hkv, Sk, Dh)),
            "v_cache": _w((lambda *s: torch.randn(*s, dtype=torch.bfloat16) * 0.4)(B, Hkv, Sk, Dh)),
            "wq": _w((lambda *s: torch.randn(*s, dtype=torch.bfloat16) * 3.2)(D, Hq * Dh) * (D ** -0.5)),
            "wo": _w((lambda *s: torch.randn(*s, dtype=torch.bfloat16) * 0.4)(Hq * Dh, D) * ((Hq * Dh) ** -0.5)),
        }
    _A_in = _A_setup()

    def _B_setup():
        B, S, D, F = 2, 1, 512, 1792
        return {
            "x": _w((lambda *s: torch.randn(*s, dtype=torch.bfloat16) * 0.05)(B, S, D)),
            "w_gate": _w((lambda *s: torch.randn(*s, dtype=torch.bfloat16) * 0.05)(D, F)),
            "w_up": _w((lambda *s: torch.randn(*s, dtype=torch.bfloat16) * 0.05)(D, F)),
            "w_down": _w((lambda *s: torch.randn(*s, dtype=torch.bfloat16) * 0.05)(F, D)),
        }
    _B_in = _B_setup()

    return {
        "A_x": _A_in["x"],
        "A_k_cache": _A_in["k_cache"],
        "A_v_cache": _A_in["v_cache"],
        "A_wq": _A_in["wq"],
        "A_wo": _A_in["wo"],
        "B_x": _B_in["x"],
        "B_w_gate": _B_in["w_gate"],
        "B_w_up": _B_in["w_up"],
        "B_w_down": _B_in["w_down"],
    }

def reference(A_x, A_k_cache, A_v_cache, A_wq, A_wo, B_x, B_w_gate, B_w_up, B_w_down):
    def _A_ref(x, k_cache, v_cache, wq, wo):
        B, Sq, D = x.shape
        Hq, Dh = 32, 128
        Hkv = k_cache.shape[1]
        rep = Hq // Hkv
        q = (lambda x, *d: x.permute(*d))((x @ wq).reshape(B, Sq, Hq, Dh), 0, 2, 1, 3)
        k = (lambda x, n, axis: torch.repeat_interleave(x, n, dim=axis))(k_cache, rep, axis=1)
        v = (lambda x, n, axis: torch.repeat_interleave(x, n, dim=axis))(v_cache, rep, axis=1)
        scores = torch.einsum("bhqd,bhkd->bhqk", q, k) * (Dh ** -0.5)
        p = _softmax(scores, axis=-1)
        o = torch.einsum("bhqk,bhkd->bhqd", p, v)
        return (lambda x, *d: x.permute(*d))(o, 0, 2, 1, 3).reshape(B, Sq, Hq * Dh) @ wo

    def _B_ref(x, w_gate, w_up, w_down):
        g = _silu(x @ w_gate)
        u = x @ w_up
        return (g * u) @ w_down

    x = A_x
    h = x + _A_ref(_layernorm(x, axis=-1), A_k_cache, A_v_cache, A_wq, A_wo)
    h2 = h + _B_ref(_layernorm(h, axis=-1), B_w_gate, B_w_up, B_w_down)
    return h2
```

```asm
; @launch grid=(256,1,1) block=(256,1,1) lds=61440
.amdgcn_target "amdgcn-amd-amdhsa--gfx950"
.text
.globl sequential_preLN__gqa_block_cached__swiglu_ffn__decode_kernel
.p2align 8
.type sequential_preLN__gqa_block_cached__swiglu_ffn__decode_kernel,@function
sequential_preLN__gqa_block_cached__swiglu_ffn__decode_kernel:
    s_cmp_ge_u32 s2, 256
    s_cbranch_scc1 L_end
    s_load_dwordx16 s[4:19], s[0:1], 0
    s_load_dwordx8 s[20:27], s[0:1], 64
    s_getpc_b64 s[28:29]
L_pc:
    v_lshlrev_b32 v12, 7, v0
    v_min_u32 v12, L_end-L_pc, v12
    global_load_dword v255, v12, s[28:29]
    v_and_b32 v1, 63, v0
    v_lshrrev_b32 v12, 6, v0
    s_and_b32 s56, s2, 7
    v_readfirstlane_b32 s58, v12
    s_lshr_b32 s57, s2, 3
    s_lshr_b32 s59, s57, 4
    s_lshl_b32 s87, s56, 5
    s_add_u32 s87, s87, s57
    v_bfe_u32 v12, v1, 2, 2
    v_lshlrev_b32 v2, 8, v12
    v_lshrrev_b32 v12, 4, v1
    v_lshl_add_u32 v2, v12, 6, v2
    v_and_b32 v12, 3, v1
    v_lshl_add_u32 v2, v12, 4, v2
    v_lshlrev_b32 v3, 4, v1
    s_lshl_b32 s78, s58, 16
    v_add_u32 v2, s78, v2
    v_add_u32 v3, s78, v3
    v_lshrrev_b32 v12, 5, v1
    v_and_b32 v13, 31, v1
    v_lshlrev_b32 v198, 10, v12
    v_lshl_add_u32 v198, v13, 4, v198
    v_lshrrev_b32 v12, 3, v1
    v_lshlrev_b32 v199, 13, v12
    v_and_b32 v12, 7, v1
    v_lshl_add_u32 v199, v12, 4, v199
    s_mul_i32 s76, s58, 1
    s_mul_i32 s79, s56, 1
    s_add_u32 s76, s76, s79
    s_mul_i32 s79, s57, 4
    s_add_u32 s76, s76, s79
    s_and_b32 s76, s76, 15
    s_lshl_b32 s79, s59, 3
    s_add_u32 s79, s79, s56
    s_lshl_b32 s79, s79, 4
    s_and_b32 s80, s57, 15
    s_add_u32 s79, s79, s80
    s_lshl_b32 s79, s79, 18
    s_lshl_b32 s80, s56, 10
    s_and_b32 s81, s57, 7
    s_lshl_b32 s81, s81, 7
    s_add_u32 s80, s80, s81
    s_lshr_b32 s81, s57, 3
    s_lshl_b32 s81, s81, 20
    s_add_u32 s80, s80, s81
    s_waitcnt lgkmcnt(0)
    s_add_u32 s28, s6, s79
    s_addc_u32 s29, s7, 0
    s_mov_b32 s30, 0x40000
    s_mov_b32 s31, 0x20000
    s_cmp_eq_u32 s58, 0
    s_cbranch_scc1 L_w0_1
    s_add_u32 s74, s76, 0
    s_and_b32 s74, s74, 15
    s_lshl_b32 s74, s74, 12
    buffer_load_dwordx4 a[0:3], v2, s[28:31], s74 offen offset:0 nt
    buffer_load_dwordx4 a[4:7], v2, s[28:31], s74 offen offset:1024 nt
    buffer_load_dwordx4 a[8:11], v2, s[28:31], s74 offen offset:2048 nt
    buffer_load_dwordx4 a[12:15], v2, s[28:31], s74 offen offset:3072 nt
    s_add_u32 s75, s76, 1
    s_and_b32 s75, s75, 15
    s_lshl_b32 s75, s75, 12
    buffer_load_dwordx4 a[16:19], v2, s[28:31], s75 offen offset:0 nt
    buffer_load_dwordx4 a[20:23], v2, s[28:31], s75 offen offset:1024 nt
    buffer_load_dwordx4 a[24:27], v2, s[28:31], s75 offen offset:2048 nt
    buffer_load_dwordx4 a[28:31], v2, s[28:31], s75 offen offset:3072 nt
    s_lshl_b32 s80, s56, 19
    s_lshr_b32 s81, s57, 1
    s_lshl_b32 s81, s81, 15
    s_add_u32 s80, s80, s81
    s_mov_b32 s44, s12
    s_mov_b32 s45, s13
    s_mov_b32 s46, 0x400000
    s_mov_b32 s47, 0x20000
    s_mov_b32 s48, s22
    s_mov_b32 s49, s23
    s_mov_b32 s50, 0x800
    s_mov_b32 s51, 0x20000
    v_mov_b32 v12, 0
    s_mov_b64 exec, 1
    buffer_load_dword v254, v12, s[44:47], s80 offen nt
    buffer_load_dword v255, v12, s[48:51], 0 offen nt
    s_mov_b64 exec, -1
    s_mov_b32 s52, s4
    s_mov_b32 s53, s5
    s_mov_b32 s54, 0x800
    s_mov_b32 s55, 0x20000
    s_mov_b32 s36, s26
    s_mov_b32 s37, s27
    s_mov_b32 s38, 0x10000000
    s_mov_b32 s39, 0x20000
    s_branch L_w0j_2
L_w0_1:
    s_mov_b32 s52, s4
    s_mov_b32 s53, s5
    s_mov_b32 s54, 0x800
    s_mov_b32 s55, 0x20000
    buffer_load_dwordx4 v[202:205], v198, s[52:55], 0 offen
    buffer_load_dwordx4 v[206:209], v198, s[52:55], 0 offen offset:512
    s_add_u32 s40, s10, s80
    s_addc_u32 s41, s11, 0
    s_mov_b32 s42, 0x400000
    s_mov_b32 s43, 0x20000
    s_sub_u32 s42, 0x400000, s80
    s_mov_b32 m0, 0
    s_mov_b32 s74, 0
    buffer_load_dwordx4 v199, s[40:43], s74 offen nt lds
    s_mov_b32 m0, 1024
    s_mov_b32 s74, 65536
    buffer_load_dwordx4 v199, s[40:43], s74 offen nt lds
    s_mov_b32 m0, 2048
    s_mov_b32 s74, 131072
    buffer_load_dwordx4 v199, s[40:43], s74 offen nt lds
    s_mov_b32 m0, 3072
    s_mov_b32 s74, 196608
    buffer_load_dwordx4 v199, s[40:43], s74 offen nt lds
    s_mov_b32 m0, 4096
    s_mov_b32 s74, 262144
    buffer_load_dwordx4 v199, s[40:43], s74 offen nt lds
    s_mov_b32 m0, 5120
    s_mov_b32 s74, 327680
    buffer_load_dwordx4 v199, s[40:43], s74 offen nt lds
    s_mov_b32 m0, 6144
    s_mov_b32 s74, 393216
    buffer_load_dwordx4 v199, s[40:43], s74 offen nt lds
    s_mov_b32 m0, 7168
    s_mov_b32 s74, 458752
    buffer_load_dwordx4 v199, s[40:43], s74 offen nt lds
    s_mov_b32 m0, 8192
    s_mov_b32 s74, 524288
    buffer_load_dwordx4 v199, s[40:43], s74 offen nt lds
    s_mov_b32 m0, 9216
    s_mov_b32 s74, 589824
    buffer_load_dwordx4 v199, s[40:43], s74 offen nt lds
    s_mov_b32 m0, 10240
    s_mov_b32 s74, 655360
    buffer_load_dwordx4 v199, s[40:43], s74 offen nt lds
    s_mov_b32 m0, 11264
    s_mov_b32 s74, 720896
    buffer_load_dwordx4 v199, s[40:43], s74 offen nt lds
    s_mov_b32 m0, 12288
    s_mov_b32 s74, 786432
    buffer_load_dwordx4 v199, s[40:43], s74 offen nt lds
    s_mov_b32 m0, 13312
    s_mov_b32 s74, 851968
    buffer_load_dwordx4 v199, s[40:43], s74 offen nt lds
    s_mov_b32 m0, 14336
    s_mov_b32 s74, 917504
    buffer_load_dwordx4 v199, s[40:43], s74 offen nt lds
    s_mov_b32 m0, 15360
    s_mov_b32 s74, 983040
    buffer_load_dwordx4 v199, s[40:43], s74 offen nt lds
    s_mov_b32 s36, s26
    s_mov_b32 s37, s27
    s_mov_b32 s38, 0x10000000
    s_mov_b32 s39, 0x20000
    s_lshl_b32 s80, s56, 15
    s_lshl_b32 s81, s59, 12
    s_add_u32 s80, s80, s81
    s_add_u32 s80, s80, 1966080
    v_and_b32 v12, 31, v1
    v_lshlrev_b32 v12, 7, v12
    v_lshrrev_b32 v13, 5, v1
    v_lshl_add_u32 v12, v13, 13, v12
    buffer_load_dword v254, v12, s[36:39], s80 offen sc1
    s_add_u32 s80, s80, 16384
    buffer_load_dword v255, v12, s[36:39], s80 offen sc1
L_w0j_2:
    s_load_dword s60, s[26:27], 0x0
    s_add_u32 s32, s8, s79
    s_addc_u32 s33, s9, 0
    s_mov_b32 s34, 0x40000
    s_mov_b32 s35, 0x20000
    s_mov_b32 s62, 0x05040100
    s_mov_b32 s63, 0x07060302
    s_mov_b32 s64, 0x07060500
    s_mov_b32 s65, 0x07060501
    s_mov_b32 s66, 0x07060502
    s_mov_b32 s67, 0x07060503
    s_mov_b32 s70, 0x3db504f3
    s_mov_b32 s71, 0x3db504f3
    s_mov_b32 s72, 0x3fb8aa3b
    s_getreg_b32 s61, hwreg(HW_REG_XCC_ID, 0, 4)
    s_cmp_lg_u32 s58, 0
    s_cbranch_scc1 L_helper
    v_add_u32 v250, 32768, v198
    v_bfe_u32 v13, v1, 2, 1
    v_lshlrev_b32 v13, 10, v13
    v_lshrrev_b32 v14, 4, v1
    v_lshl_add_u32 v13, v14, 4, v13
    s_bfe_u32 s79, s57, 0x10003
    s_lshl_b32 s79, s79, 8
    s_add_u32 s79, s79, 32768
    v_add_u32 v251, s79, v13
    v_bfe_u32 v15, v1, 2, 2
    v_lshl_add_u32 v15, v14, 3, v15
    v_lshlrev_b32 v15, 7, v15
    v_and_b32 v14, 3, v1
    v_lshl_add_u32 v252, v14, 3, v15
    v_lshrrev_b32 v12, 4, v1
    v_lshlrev_b32 v12, 12, v12
    v_and_b32 v13, 15, v1
    v_lshl_add_u32 v253, v13, 3, v12
    s_waitcnt lgkmcnt(0)
    s_and_b32 s78, s60, 0xff
    s_add_u32 s79, s78, 0x35
    s_and_b32 s79, s79, 0xff
    s_lshl_b32 s79, s79, 8
    s_add_u32 s80, s78, 0x6a
    s_and_b32 s80, s80, 0xff
    s_lshl_b32 s80, s80, 16
    s_add_u32 s81, s78, 0xc1
    s_lshl_b32 s81, s81, 24
    s_or_b32 s78, s78, s79
    s_or_b32 s80, s80, s81
    s_or_b32 s78, s78, s80
    s_add_u32 s86, s60, 1
    s_mov_b32 s60, s78
    v_mov_b32 v196, s78
    s_bfe_u32 s68, s78, 0x80000
    s_bfe_u32 s69, s78, 0x80008
    s_bfe_u32 s3, s78, 0x80010
    s_bfe_u32 s27, s78, 0x80018
    s_lshr_b32 s78, s57, 3
    s_lshl_b32 s80, s56, 2
    s_add_u32 s78, s78, s80
    s_lshl_b32 s78, s78, 13
    s_and_b32 s80, s57, 7
    s_lshl_b32 s80, s80, 9
    s_add_u32 s78, s78, s80
    s_add_u32 s78, s78, 1703936
    s_add_u32 s79, s78, 262144
    s_and_b32 s81, s60, 0xfffffff0
    s_or_b32 s81, s81, s61
    s_waitcnt vmcnt(18)
    v_lshlrev_b32 v16, 16, v202
    v_and_b32 v17, 0xffff0000, v202
    v_lshlrev_b32 v18, 16, v203
    v_and_b32 v19, 0xffff0000, v203
    v_lshlrev_b32 v20, 16, v204
    v_and_b32 v21, 0xffff0000, v204
    v_lshlrev_b32 v22, 16, v205
    v_and_b32 v23, 0xffff0000, v205
    v_lshlrev_b32 v24, 16, v206
    v_and_b32 v25, 0xffff0000, v206
    v_lshlrev_b32 v26, 16, v207
    v_and_b32 v27, 0xffff0000, v207
    v_lshlrev_b32 v28, 16, v208
    v_and_b32 v29, 0xffff0000, v208
    v_lshlrev_b32 v30, 16, v209
    v_and_b32 v31, 0xffff0000, v209
    v_pk_add_f32 v[32:33], v[16:17], v[18:19]
    v_pk_add_f32 v[34:35], v[20:21], v[22:23]
    v_pk_add_f32 v[32:33], v[32:33], v[24:25]
    v_pk_add_f32 v[34:35], v[34:35], v[26:27]
    v_pk_add_f32 v[32:33], v[32:33], v[28:29]
    v_pk_add_f32 v[34:35], v[34:35], v[30:31]
    v_pk_add_f32 v[32:33], v[32:33], v[34:35]
    v_add_f32 v32, v32, v33
    s_nop 1
    v_add_f32_dpp v32, v32, v32 row_ror:8 row_mask:0xf bank_mask:0xf
    s_nop 1
    v_add_f32_dpp v32, v32, v32 row_ror:4 row_mask:0xf bank_mask:0xf
    s_nop 1
    v_add_f32_dpp v32, v32, v32 row_ror:2 row_mask:0xf bank_mask:0xf
    s_nop 1
    v_add_f32_dpp v32, v32, v32 row_ror:1 row_mask:0xf bank_mask:0xf
    v_mov_b32 v12, v32
    s_nop 1
    v_permlane16_swap_b32 v32, v12
    v_add_f32 v32, v32, v12
    v_mul_f32 v32, 0x3b000000, v32
    v_mov_b32 v33, v32
    v_pk_add_f32 v[36:37], v[16:17], v[32:33] neg_lo:[0,1] neg_hi:[0,1]
    v_pk_add_f32 v[38:39], v[18:19], v[32:33] neg_lo:[0,1] neg_hi:[0,1]
    v_pk_add_f32 v[40:41], v[20:21], v[32:33] neg_lo:[0,1] neg_hi:[0,1]
    v_pk_add_f32 v[42:43], v[22:23], v[32:33] neg_lo:[0,1] neg_hi:[0,1]
    v_pk_add_f32 v[44:45], v[24:25], v[32:33] neg_lo:[0,1] neg_hi:[0,1]
    v_pk_add_f32 v[46:47], v[26:27], v[32:33] neg_lo:[0,1] neg_hi:[0,1]
    v_pk_add_f32 v[48:49], v[28:29], v[32:33] neg_lo:[0,1] neg_hi:[0,1]
    v_pk_add_f32 v[50:51], v[30:31], v[32:33] neg_lo:[0,1] neg_hi:[0,1]
    v_pk_mul_f32 v[52:53], v[36:37], v[36:37]
    v_pk_mul_f32 v[54:55], v[38:39], v[38:39]
    v_pk_fma_f32 v[52:53], v[40:41], v[40:41], v[52:53]
    v_pk_fma_f32 v[54:55], v[42:43], v[42:43], v[54:55]
    v_pk_fma_f32 v[52:53], v[44:45], v[44:45], v[52:53]
    v_pk_fma_f32 v[54:55], v[46:47], v[46:47], v[54:55]
    v_pk_fma_f32 v[52:53], v[48:49], v[48:49], v[52:53]
    v_pk_fma_f32 v[54:55], v[50:51], v[50:51], v[54:55]
    v_pk_add_f32 v[52:53], v[52:53], v[54:55]
    v_add_f32 v52, v52, v53
    s_nop 1
    v_add_f32_dpp v52, v52, v52 row_ror:8 row_mask:0xf bank_mask:0xf
    s_nop 1
    v_add_f32_dpp v52, v52, v52 row_ror:4 row_mask:0xf bank_mask:0xf
    s_nop 1
    v_add_f32_dpp v52, v52, v52 row_ror:2 row_mask:0xf bank_mask:0xf
    s_nop 1
    v_add_f32_dpp v52, v52, v52 row_ror:1 row_mask:0xf bank_mask:0xf
    v_mov_b32 v12, v52
    s_nop 1
    v_permlane16_swap_b32 v52, v12
    v_add_f32 v52, v52, v12
    s_cmp_lt_u32 s57, 16
    s_cbranch_scc1 L_lo_3
    v_mov_b32 v16, v24
    v_mov_b32 v17, v25
    v_mov_b32 v18, v26
    v_mov_b32 v19, v27
    v_mov_b32 v20, v28
    v_mov_b32 v21, v29
    v_mov_b32 v22, v30
    v_mov_b32 v23, v31
L_lo_3:
    v_mul_f32 v52, 0x3b000000, v52
    v_cvt_pk_bf16_f32 v12, v32, v52
    v_lshlrev_b32 v32, 16, v12
    v_and_b32 v52, 0xffff0000, v12
    v_add_f32 v52, 0x3727c5ac, v52
    v_mov_b32 v33, v32
    v_cvt_pk_bf16_f32 v52, v52, v52
    v_lshlrev_b32 v52, 16, v52
    v_pk_add_f32 v[36:37], v[16:17], v[32:33] neg_lo:[0,1] neg_hi:[0,1]
    v_pk_add_f32 v[38:39], v[18:19], v[32:33] neg_lo:[0,1] neg_hi:[0,1]
    v_pk_add_f32 v[40:41], v[20:21], v[32:33] neg_lo:[0,1] neg_hi:[0,1]
    v_pk_add_f32 v[42:43], v[22:23], v[32:33] neg_lo:[0,1] neg_hi:[0,1]
    v_sqrt_f32 v52, v52
    v_cvt_pk_bf16_f32 v202, v36, v37
    v_cvt_pk_bf16_f32 v203, v38, v39
    v_cvt_pk_bf16_f32 v204, v40, v41
    v_cvt_pk_bf16_f32 v205, v42, v43
    v_cvt_pk_bf16_f32 v52, v52, v52
    v_lshlrev_b32 v52, 16, v52
    v_rcp_f32 v54, v52
    v_mov_b32 v53, v52
    v_lshlrev_b32 v36, 16, v202
    v_and_b32 v37, 0xffff0000, v202
    v_lshlrev_b32 v38, 16, v203
    v_and_b32 v39, 0xffff0000, v203
    v_lshlrev_b32 v40, 16, v204
    v_and_b32 v41, 0xffff0000, v204
    v_lshlrev_b32 v42, 16, v205
    v_and_b32 v43, 0xffff0000, v205
    v_mov_b32 v55, v54
    v_pk_mul_f32 v[16:17], v[36:37], v[54:55]
    v_pk_mul_f32 v[18:19], v[38:39], v[54:55]
    v_pk_mul_f32 v[20:21], v[40:41], v[54:55]
    v_pk_mul_f32 v[22:23], v[42:43], v[54:55]
    v_pk_fma_f32 v[36:37], v[16:17], v[52:53], v[36:37] neg_lo:[1,0,0] neg_hi:[1,0,0]
    v_pk_fma_f32 v[38:39], v[18:19], v[52:53], v[38:39] neg_lo:[1,0,0] neg_hi:[1,0,0]
    v_pk_fma_f32 v[40:41], v[20:21], v[52:53], v[40:41] neg_lo:[1,0,0] neg_hi:[1,0,0]
    v_pk_fma_f32 v[42:43], v[22:23], v[52:53], v[42:43] neg_lo:[1,0,0] neg_hi:[1,0,0]
    v_pk_fma_f32 v[16:17], v[36:37], v[54:55], v[16:17]
    v_pk_fma_f32 v[18:19], v[38:39], v[54:55], v[18:19]
    v_pk_fma_f32 v[20:21], v[40:41], v[54:55], v[20:21]
    v_pk_fma_f32 v[22:23], v[42:43], v[54:55], v[22:23]
    v_cvt_pk_bf16_f32 v202, v16, v17
    v_cvt_pk_bf16_f32 v203, v18, v19
    v_cvt_pk_bf16_f32 v204, v20, v21
    v_cvt_pk_bf16_f32 v205, v22, v23
    ds_write_b128 v250, v[202:205]
    s_waitcnt lgkmcnt(0)
    ds_read_b128 v[210:213], v251 offset:0
    ds_read_b128 v[214:217], v251 offset:64
    ds_read_b128 v[218:221], v251 offset:128
    ds_read_b128 v[222:225], v251 offset:192
    s_waitcnt vmcnt(2)
    s_waitcnt lgkmcnt(0)
    ds_read_b64_tr_b16 v[16:17], v252 offset:0
    ds_read_b64_tr_b16 v[18:19], v252 offset:512
    ds_read_b64_tr_b16 v[20:21], v252 offset:4096
    ds_read_b64_tr_b16 v[22:23], v252 offset:4608
    ds_read_b64_tr_b16 v[24:25], v252 offset:8192
    ds_read_b64_tr_b16 v[26:27], v252 offset:8704
    ds_read_b64_tr_b16 v[28:29], v252 offset:12288
    ds_read_b64_tr_b16 v[30:31], v252 offset:12800
    s_waitcnt lgkmcnt(4)
    ds_read_b64_tr_b16 v[32:33], v252 offset:32
    ds_read_b64_tr_b16 v[34:35], v252 offset:544
    ds_read_b64_tr_b16 v[36:37], v252 offset:4128
    ds_read_b64_tr_b16 v[38:39], v252 offset:4640
    ds_read_b64_tr_b16 v[40:41], v252 offset:8224
    ds_read_b64_tr_b16 v[42:43], v252 offset:8736
    ds_read_b64_tr_b16 v[44:45], v252 offset:12320
    ds_read_b64_tr_b16 v[46:47], v252 offset:12832
    s_waitcnt lgkmcnt(8)
    v_mfma_f32_16x16x32_bf16 v[226:229], v[210:213], v[16:19], 0
    v_mfma_f32_16x16x32_bf16 v[226:229], v[214:217], v[20:23], v[226:229]
    v_mfma_f32_16x16x32_bf16 v[226:229], v[218:221], v[24:27], v[226:229]
    v_mfma_f32_16x16x32_bf16 v[226:229], v[222:225], v[28:31], v[226:229]
    s_waitcnt lgkmcnt(4)
    ds_read_b64_tr_b16 v[48:49], v252 offset:64
    ds_read_b64_tr_b16 v[50:51], v252 offset:576
    ds_read_b64_tr_b16 v[52:53], v252 offset:4160
    ds_read_b64_tr_b16 v[54:55], v252 offset:4672
    ds_read_b64_tr_b16 v[56:57], v252 offset:8256
    ds_read_b64_tr_b16 v[58:59], v252 offset:8768
    ds_read_b64_tr_b16 v[60:61], v252 offset:12352
    ds_read_b64_tr_b16 v[62:63], v252 offset:12864
    s_waitcnt lgkmcnt(8)
    v_mfma_f32_16x16x32_bf16 v[230:233], v[210:213], v[32:35], 0
    v_mfma_f32_16x16x32_bf16 v[230:233], v[214:217], v[36:39], v[230:233]
    v_mfma_f32_16x16x32_bf16 v[230:233], v[218:221], v[40:43], v[230:233]
    v_mfma_f32_16x16x32_bf16 v[230:233], v[222:225], v[44:47], v[230:233]
    s_waitcnt lgkmcnt(4)
    ds_read_b64_tr_b16 v[64:65], v252 offset:96
    ds_read_b64_tr_b16 v[66:67], v252 offset:608
    ds_read_b64_tr_b16 v[68:69], v252 offset:4192
    ds_read_b64_tr_b16 v[70:71], v252 offset:4704
    ds_read_b64_tr_b16 v[72:73], v252 offset:8288
    ds_read_b64_tr_b16 v[74:75], v252 offset:8800
    ds_read_b64_tr_b16 v[76:77], v252 offset:12384
    ds_read_b64_tr_b16 v[78:79], v252 offset:12896
    s_waitcnt lgkmcnt(8)
    v_mfma_f32_16x16x32_bf16 v[234:237], v[210:213], v[48:51], 0
    v_mfma_f32_16x16x32_bf16 v[234:237], v[214:217], v[52:55], v[234:237]
    v_mfma_f32_16x16x32_bf16 v[234:237], v[218:221], v[56:59], v[234:237]
    v_mfma_f32_16x16x32_bf16 v[234:237], v[222:225], v[60:63], v[234:237]
    s_waitcnt lgkmcnt(0)
    v_mfma_f32_16x16x32_bf16 v[238:241], v[210:213], v[64:67], 0
    v_mfma_f32_16x16x32_bf16 v[238:241], v[214:217], v[68:71], v[238:241]
    v_mfma_f32_16x16x32_bf16 v[238:241], v[218:221], v[72:75], v[238:241]
    v_mfma_f32_16x16x32_bf16 v[238:241], v[222:225], v[76:79], v[238:241]
    v_mov_b32_dpp v16, v226 quad_perm:[0,0,2,2] row_mask:0xf bank_mask:0xf
    v_mov_b32_dpp v18, v226 quad_perm:[1,1,3,3] row_mask:0xf bank_mask:0xf
    v_mov_b32 v17, v196
    v_mov_b32 v19, s81
    v_mov_b32_dpp v20, v230 quad_perm:[0,0,2,2] row_mask:0xf bank_mask:0xf
    v_mov_b32_dpp v22, v230 quad_perm:[1,1,3,3] row_mask:0xf bank_mask:0xf
    v_mov_b32 v21, v196
    v_mov_b32 v23, s81
    v_mov_b32_dpp v24, v234 quad_perm:[0,0,2,2] row_mask:0xf bank_mask:0xf
    v_mov_b32_dpp v26, v234 quad_perm:[1,1,3,3] row_mask:0xf bank_mask:0xf
    v_mov_b32 v25, v196
    v_mov_b32 v27, s81
    v_mov_b32_dpp v28, v238 quad_perm:[0,0,2,2] row_mask:0xf bank_mask:0xf
    v_mov_b32_dpp v30, v238 quad_perm:[1,1,3,3] row_mask:0xf bank_mask:0xf
    v_mov_b32 v29, v196
    v_mov_b32 v31, s81
    s_mov_b32 exec_lo, 0x55555555
    s_mov_b32 exec_hi, 0
    buffer_store_dwordx4 v[16:19], v253, s[36:39], s79 offen offset:0
    buffer_store_dwordx4 v[20:23], v253, s[36:39], s79 offen offset:128
    buffer_store_dwordx4 v[24:27], v253, s[36:39], s79 offen offset:256
    buffer_store_dwordx4 v[28:31], v253, s[36:39], s79 offen offset:384
    buffer_store_dwordx4 v[16:19], v253, s[36:39], s78 offen offset:0 sc1
    buffer_store_dwordx4 v[20:23], v253, s[36:39], s78 offen offset:128 sc1
    buffer_store_dwordx4 v[24:27], v253, s[36:39], s78 offen offset:256 sc1
    buffer_store_dwordx4 v[28:31], v253, s[36:39], s78 offen offset:384 sc1
    s_mov_b64 exec, -1
    v_lshlrev_b32 v201, 4, v1
    s_lshl_b32 s78, s56, 15
    s_lshl_b32 s79, s59, 12
    s_add_u32 s78, s78, s79
    s_add_u32 s82, s78, 1703936
    s_add_u32 s83, s78, 1966080
    v_mov_b32 v200, s81
    s_add_u32 s74, s76, 0
    s_and_b32 s74, s74, 15
    s_lshl_b32 s74, s74, 12
    buffer_load_dwordx4 a[0:3], v2, s[28:31], s74 offen offset:0 nt
    buffer_load_dwordx4 a[4:7], v2, s[28:31], s74 offen offset:1024 nt
    buffer_load_dwordx4 a[8:11], v2, s[28:31], s74 offen offset:2048 nt
    buffer_load_dwordx4 a[12:15], v2, s[28:31], s74 offen offset:3072 nt
    s_add_u32 s75, s76, 1
    s_and_b32 s75, s75, 15
    s_lshl_b32 s75, s75, 12
    buffer_load_dwordx4 a[16:19], v2, s[28:31], s75 offen offset:0 nt
    buffer_load_dwordx4 a[20:23], v2, s[28:31], s75 offen offset:1024 nt
    buffer_load_dwordx4 a[24:27], v2, s[28:31], s75 offen offset:2048 nt
    buffer_load_dwordx4 a[28:31], v2, s[28:31], s75 offen offset:3072 nt
    s_waitcnt vmcnt(12)
    s_add_u32 s80, s83, 0
    buffer_load_dwordx4 v[16:19], v201, s[36:39], s80 offen offset:0 sc1
    buffer_load_dwordx4 v[20:23], v201, s[36:39], s80 offen offset:1024 sc1
    buffer_load_dwordx4 v[24:27], v201, s[36:39], s80 offen offset:2048 sc1
    buffer_load_dwordx4 v[28:31], v201, s[36:39], s80 offen offset:3072 sc1
    s_add_u32 s80, s83, 8192
    buffer_load_dwordx4 v[32:35], v201, s[36:39], s80 offen offset:0 sc1
    buffer_load_dwordx4 v[36:39], v201, s[36:39], s80 offen offset:1024 sc1
    buffer_load_dwordx4 v[40:43], v201, s[36:39], s80 offen offset:2048 sc1
    buffer_load_dwordx4 v[44:47], v201, s[36:39], s80 offen offset:3072 sc1
    s_add_u32 s80, s83, 16384
    buffer_load_dwordx4 v[48:51], v201, s[36:39], s80 offen offset:0 sc1
    buffer_load_dwordx4 v[52:55], v201, s[36:39], s80 offen offset:1024 sc1
    buffer_load_dwordx4 v[56:59], v201, s[36:39], s80 offen offset:2048 sc1
    buffer_load_dwordx4 v[60:63], v201, s[36:39], s80 offen offset:3072 sc1
    s_add_u32 s80, s83, 24576
    buffer_load_dwordx4 v[64:67], v201, s[36:39], s80 offen offset:0 sc1
    buffer_load_dwordx4 v[68:71], v201, s[36:39], s80 offen offset:1024 sc1
    buffer_load_dwordx4 v[72:75], v201, s[36:39], s80 offen offset:2048 sc1
    buffer_load_dwordx4 v[76:79], v201, s[36:39], s80 offen offset:3072 sc1
    s_add_u32 s74, s76, 0
    s_and_b32 s74, s74, 15
    s_lshl_b32 s74, s74, 12
    buffer_load_dwordx4 v[80:83], v3, s[32:35], s74 offen offset:0 nt
    buffer_load_dwordx4 v[84:87], v3, s[32:35], s74 offen offset:1024 nt
    buffer_load_dwordx4 v[88:91], v3, s[32:35], s74 offen offset:2048 nt
    buffer_load_dwordx4 v[92:95], v3, s[32:35], s74 offen offset:3072 nt
    s_add_u32 s75, s76, 1
    s_and_b32 s75, s75, 15
    s_lshl_b32 s75, s75, 12
    buffer_load_dwordx4 v[96:99], v3, s[32:35], s75 offen offset:0 nt
    buffer_load_dwordx4 v[100:103], v3, s[32:35], s75 offen offset:1024 nt
    buffer_load_dwordx4 v[104:107], v3, s[32:35], s75 offen offset:2048 nt
    buffer_load_dwordx4 v[108:111], v3, s[32:35], s75 offen offset:3072 nt
    s_waitcnt vmcnt(8)
    v_xor_b32 v12, v17, v196
    v_xor_b32 v13, v19, v200
    v_xor_b32 v14, v21, v196
    v_xor_b32 v15, v23, v200
    v_or_b32 v12, v12, v14
    v_or_b32 v13, v13, v15
    v_xor_b32 v14, v25, v196
    v_xor_b32 v15, v27, v200
    v_or_b32 v12, v12, v14
    v_or_b32 v13, v13, v15
    v_xor_b32 v14, v29, v196
    v_xor_b32 v15, v31, v200
    v_or_b32 v12, v12, v14
    v_or_b32 v13, v13, v15
    v_xor_b32 v14, v33, v196
    v_xor_b32 v15, v35, v200
    v_or_b32 v12, v12, v14
    v_or_b32 v13, v13, v15
    v_xor_b32 v14, v37, v196
    v_xor_b32 v15, v39, v200
    v_or_b32 v12, v12, v14
    v_or_b32 v13, v13, v15
    v_xor_b32 v14, v41, v196
    v_xor_b32 v15, v43, v200
    v_or_b32 v12, v12, v14
    v_or_b32 v13, v13, v15
    v_xor_b32 v14, v45, v196
    v_xor_b32 v15, v47, v200
    v_or_b32 v12, v12, v14
    v_or_b32 v13, v13, v15
    v_xor_b32 v14, v49, v196
    v_xor_b32 v15, v51, v200
    v_or_b32 v12, v12, v14
    v_or_b32 v13, v13, v15
    v_xor_b32 v14, v53, v196
    v_xor_b32 v15, v55, v200
    v_or_b32 v12, v12, v14
    v_or_b32 v13, v13, v15
    v_xor_b32 v14, v57, v196
    v_xor_b32 v15, v59, v200
    v_or_b32 v12, v12, v14
    v_or_b32 v13, v13, v15
    v_xor_b32 v14, v61, v196
    v_xor_b32 v15, v63, v200
    v_or_b32 v12, v12, v14
    v_or_b32 v13, v13, v15
    v_xor_b32 v14, v65, v196
    v_xor_b32 v15, v67, v200
    v_or_b32 v12, v12, v14
    v_or_b32 v13, v13, v15
    v_xor_b32 v14, v69, v196
    v_xor_b32 v15, v71, v200
    v_or_b32 v12, v12, v14
    v_or_b32 v13, v13, v15
    v_xor_b32 v14, v73, v196
    v_xor_b32 v15, v75, v200
    v_or_b32 v12, v12, v14
    v_or_b32 v13, v13, v15
    v_xor_b32 v14, v77, v196
    v_xor_b32 v15, v79, v200
    v_or_b32 v12, v12, v14
    v_or_b32 v13, v13, v15
    v_lshrrev_b32 v14, 4, v13
    v_or_b32 v12, v12, v14
    v_cmp_eq_u32 vcc, 0, v13
    s_nop 0
    s_cmp_eq_u64 vcc, -1
    s_cselect_b32 s77, 1, 0
    v_cmp_eq_u32 vcc, 0, v12
    s_nop 0
    s_cmp_eq_u64 vcc, -1
    s_cbranch_scc1 L_qok_4
    s_add_u32 s80, s83, 0
    buffer_load_dwordx4 v[16:19], v201, s[36:39], s80 offen offset:0 sc1
    buffer_load_dwordx4 v[20:23], v201, s[36:39], s80 offen offset:1024 sc1
    buffer_load_dwordx4 v[24:27], v201, s[36:39], s80 offen offset:2048 sc1
    buffer_load_dwordx4 v[28:31], v201, s[36:39], s80 offen offset:3072 sc1
    s_add_u32 s80, s83, 8192
    buffer_load_dwordx4 v[32:35], v201, s[36:39], s80 offen offset:0 sc1
    buffer_load_dwordx4 v[36:39], v201, s[36:39], s80 offen offset:1024 sc1
    buffer_load_dwordx4 v[40:43], v201, s[36:39], s80 offen offset:2048 sc1
    buffer_load_dwordx4 v[44:47], v201, s[36:39], s80 offen offset:3072 sc1
    s_add_u32 s80, s83, 16384
    buffer_load_dwordx4 v[48:51], v201, s[36:39], s80 offen offset:0 sc1
    buffer_load_dwordx4 v[52:55], v201, s[36:39], s80 offen offset:1024 sc1
    buffer_load_dwordx4 v[56:59], v201, s[36:39], s80 offen offset:2048 sc1
    buffer_load_dwordx4 v[60:63], v201, s[36:39], s80 offen offset:3072 sc1
    s_add_u32 s80, s83, 24576
    buffer_load_dwordx4 v[64:67], v201, s[36:39], s80 offen offset:0 sc1
    buffer_load_dwordx4 v[68:71], v201, s[36:39], s80 offen offset:1024 sc1
    buffer_load_dwordx4 v[72:75], v201, s[36:39], s80 offen offset:2048 sc1
    buffer_load_dwordx4 v[76:79], v201, s[36:39], s80 offen offset:3072 sc1
    s_add_u32 s74, s76, 2
    s_and_b32 s74, s74, 15
    s_lshl_b32 s74, s74, 12
    buffer_load_dwordx4 a[32:35], v2, s[28:31], s74 offen offset:0 nt
    buffer_load_dwordx4 a[36:39], v2, s[28:31], s74 offen offset:1024 nt
    buffer_load_dwordx4 a[40:43], v2, s[28:31], s74 offen offset:2048 nt
    buffer_load_dwordx4 a[44:47], v2, s[28:31], s74 offen offset:3072 nt
    s_add_u32 s75, s76, 3
    s_and_b32 s75, s75, 15
    s_lshl_b32 s75, s75, 12
    buffer_load_dwordx4 a[48:51], v2, s[28:31], s75 offen offset:0 nt
    buffer_load_dwordx4 a[52:55], v2, s[28:31], s75 offen offset:1024 nt
    buffer_load_dwordx4 a[56:59], v2, s[28:31], s75 offen offset:2048 nt
    buffer_load_dwordx4 a[60:63], v2, s[28:31], s75 offen offset:3072 nt
    s_waitcnt vmcnt(8)
    v_xor_b32 v12, v17, v196
    v_xor_b32 v13, v19, v200
    v_xor_b32 v14, v21, v196
    v_xor_b32 v15, v23, v200
    v_or_b32 v12, v12, v14
    v_or_b32 v13, v13, v15
    v_xor_b32 v14, v25, v196
    v_xor_b32 v15, v27, v200
    v_or_b32 v12, v12, v14
    v_or_b32 v13, v13, v15
    v_xor_b32 v14, v29, v196
    v_xor_b32 v15, v31, v200
    v_or_b32 v12, v12, v14
    v_or_b32 v13, v13, v15
    v_xor_b32 v14, v33, v196
    v_xor_b32 v15, v35, v200
    v_or_b32 v12, v12, v14
    v_or_b32 v13, v13, v15
    v_xor_b32 v14, v37, v196
    v_xor_b32 v15, v39, v200
    v_or_b32 v12, v12, v14
    v_or_b32 v13, v13, v15
    v_xor_b32 v14, v41, v196
    v_xor_b32 v15, v43, v200
    v_or_b32 v12, v12, v14
    v_or_b32 v13, v13, v15
    v_xor_b32 v14, v45, v196
    v_xor_b32 v15, v47, v200
    v_or_b32 v12, v12, v14
    v_or_b32 v13, v13, v15
    v_xor_b32 v14, v49, v196
    v_xor_b32 v15, v51, v200
    v_or_b32 v12, v12, v14
    v_or_b32 v13, v13, v15
    v_xor_b32 v14, v53, v196
    v_xor_b32 v15, v55, v200
    v_or_b32 v12, v12, v14
    v_or_b32 v13, v13, v15
    v_xor_b32 v14, v57, v196
    v_xor_b32 v15, v59, v200
    v_or_b32 v12, v12, v14
    v_or_b32 v13, v13, v15
    v_xor_b32 v14, v61, v196
    v_xor_b32 v15, v63, v200
    v_or_b32 v12, v12, v14
    v_or_b32 v13, v13, v15
    v_xor_b32 v14, v65, v196
    v_xor_b32 v15, v67, v200
    v_or_b32 v12, v12, v14
    v_or_b32 v13, v13, v15
    v_xor_b32 v14, v69, v196
    v_xor_b32 v15, v71, v200
    v_or_b32 v12, v12, v14
    v_or_b32 v13, v13, v15
    v_xor_b32 v14, v73, v196
    v_xor_b32 v15, v75, v200
    v_or_b32 v12, v12, v14
    v_or_b32 v13, v13, v15
    v_xor_b32 v14, v77, v196
    v_xor_b32 v15, v79, v200
    v_or_b32 v12, v12, v14
    v_or_b32 v13, v13, v15
    v_lshrrev_b32 v14, 4, v13
    v_or_b32 v12, v12, v14
    v_cmp_eq_u32 vcc, 0, v13
    s_nop 0
    s_cmp_eq_u64 vcc, -1
    s_cselect_b32 s77, 1, 0
    v_cmp_eq_u32 vcc, 0, v12
    s_nop 0
    s_cmp_eq_u64 vcc, -1
    s_cbranch_scc1 L_qok_5
    s_add_u32 s80, s83, 0
    buffer_load_dwordx4 v[16:19], v201, s[36:39], s80 offen offset:0 sc1
    buffer_load_dwordx4 v[20:23], v201, s[36:39], s80 offen offset:1024 sc1
    buffer_load_dwordx4 v[24:27], v201, s[36:39], s80 offen offset:2048 sc1
    buffer_load_dwordx4 v[28:31], v201, s[36:39], s80 offen offset:3072 sc1
    s_add_u32 s80, s83, 8192
    buffer_load_dwordx4 v[32:35], v201, s[36:39], s80 offen offset:0 sc1
    buffer_load_dwordx4 v[36:39], v201, s[36:39], s80 offen offset:1024 sc1
    buffer_load_dwordx4 v[40:43], v201, s[36:39], s80 offen offset:2048 sc1
    buffer_load_dwordx4 v[44:47], v201, s[36:39], s80 offen offset:3072 sc1
    s_add_u32 s80, s83, 16384
    buffer_load_dwordx4 v[48:51], v201, s[36:39], s80 offen offset:0 sc1
    buffer_load_dwordx4 v[52:55], v201, s[36:39], s80 offen offset:1024 sc1
    buffer_load_dwordx4 v[56:59], v201, s[36:39], s80 offen offset:2048 sc1
    buffer_load_dwordx4 v[60:63], v201, s[36:39], s80 offen offset:3072 sc1
    s_add_u32 s80, s83, 24576
    buffer_load_dwordx4 v[64:67], v201, s[36:39], s80 offen offset:0 sc1
    buffer_load_dwordx4 v[68:71], v201, s[36:39], s80 offen offset:1024 sc1
    buffer_load_dwordx4 v[72:75], v201, s[36:39], s80 offen offset:2048 sc1
    buffer_load_dwordx4 v[76:79], v201, s[36:39], s80 offen offset:3072 sc1
    s_add_u32 s74, s76, 2
    s_and_b32 s74, s74, 15
    s_lshl_b32 s74, s74, 12
    buffer_load_dwordx4 v[112:115], v3, s[32:35], s74 offen offset:0 nt
    buffer_load_dwordx4 v[116:119], v3, s[32:35], s74 offen offset:1024 nt
    buffer_load_dwordx4 v[120:123], v3, s[32:35], s74 offen offset:2048 nt
    buffer_load_dwordx4 v[124:127], v3, s[32:35], s74 offen offset:3072 nt
    s_add_u32 s75, s76, 3
    s_and_b32 s75, s75, 15
    s_lshl_b32 s75, s75, 12
    buffer_load_dwordx4 v[128:131], v3, s[32:35], s75 offen offset:0 nt
    buffer_load_dwordx4 v[132:135], v3, s[32:35], s75 offen offset:1024 nt
    buffer_load_dwordx4 v[136:139], v3, s[32:35], s75 offen offset:2048 nt
    buffer_load_dwordx4 v[140:143], v3, s[32:35], s75 offen offset:3072 nt
    s_waitcnt vmcnt(8)
    v_xor_b32 v12, v17, v196
    v_xor_b32 v13, v19, v200
    v_xor_b32 v14, v21, v196
    v_xor_b32 v15, v23, v200
    v_or_b32 v12, v12, v14
    v_or_b32 v13, v13, v15
    v_xor_b32 v14, v25, v196
    v_xor_b32 v15, v27, v200
    v_or_b32 v12, v12, v14
    v_or_b32 v13, v13, v15
    v_xor_b32 v14, v29, v196
    v_xor_b32 v15, v31, v200
    v_or_b32 v12, v12, v14
    v_or_b32 v13, v13, v15
    v_xor_b32 v14, v33, v196
    v_xor_b32 v15, v35, v200
    v_or_b32 v12, v12, v14
    v_or_b32 v13, v13, v15
    v_xor_b32 v14, v37, v196
    v_xor_b32 v15, v39, v200
    v_or_b32 v12, v12, v14
    v_or_b32 v13, v13, v15
    v_xor_b32 v14, v41, v196
    v_xor_b32 v15, v43, v200
    v_or_b32 v12, v12, v14
    v_or_b32 v13, v13, v15
    v_xor_b32 v14, v45, v196
    v_xor_b32 v15, v47, v200
    v_or_b32 v12, v12, v14
    v_or_b32 v13, v13, v15
    v_xor_b32 v14, v49, v196
    v_xor_b32 v15, v51, v200
    v_or_b32 v12, v12, v14
    v_or_b32 v13, v13, v15
    v_xor_b32 v14, v53, v196
    v_xor_b32 v15, v55, v200
    v_or_b32 v12, v12, v14
    v_or_b32 v13, v13, v15
    v_xor_b32 v14, v57, v196
    v_xor_b32 v15, v59, v200
    v_or_b32 v12, v12, v14
    v_or_b32 v13, v13, v15
    v_xor_b32 v14, v61, v196
    v_xor_b32 v15, v63, v200
    v_or_b32 v12, v12, v14
    v_or_b32 v13, v13, v15
    v_xor_b32 v14, v65, v196
    v_xor_b32 v15, v67, v200
    v_or_b32 v12, v12, v14
    v_or_b32 v13, v13, v15
    v_xor_b32 v14, v69, v196
    v_xor_b32 v15, v71, v200
    v_or_b32 v12, v12, v14
    v_or_b32 v13, v13, v15
    v_xor_b32 v14, v73, v196
    v_xor_b32 v15, v75, v200
    v_or_b32 v12, v12, v14
    v_or_b32 v13, v13, v15
    v_xor_b32 v14, v77, v196
    v_xor_b32 v15, v79, v200
    v_or_b32 v12, v12, v14
    v_or_b32 v13, v13, v15
    v_lshrrev_b32 v14, 4, v13
    v_or_b32 v12, v12, v14
    v_cmp_eq_u32 vcc, 0, v13
    s_nop 0
    s_cmp_eq_u64 vcc, -1
    s_cselect_b32 s77, 1, 0
    v_cmp_eq_u32 vcc, 0, v12
    s_nop 0
    s_cmp_eq_u64 vcc, -1
    s_cbranch_scc1 L_qok_6
    s_add_u32 s80, s83, 0
    buffer_load_dwordx4 v[16:19], v201, s[36:39], s80 offen offset:0 sc1
    buffer_load_dwordx4 v[20:23], v201, s[36:39], s80 offen offset:1024 sc1
    buffer_load_dwordx4 v[24:27], v201, s[36:39], s80 offen offset:2048 sc1
    buffer_load_dwordx4 v[28:31], v201, s[36:39], s80 offen offset:3072 sc1
    s_add_u32 s80, s83, 8192
    buffer_load_dwordx4 v[32:35], v201, s[36:39], s80 offen offset:0 sc1
    buffer_load_dwordx4 v[36:39], v201, s[36:39], s80 offen offset:1024 sc1
    buffer_load_dwordx4 v[40:43], v201, s[36:39], s80 offen offset:2048 sc1
    buffer_load_dwordx4 v[44:47], v201, s[36:39], s80 offen offset:3072 sc1
    s_add_u32 s80, s83, 16384
    buffer_load_dwordx4 v[48:51], v201, s[36:39], s80 offen offset:0 sc1
    buffer_load_dwordx4 v[52:55], v201, s[36:39], s80 offen offset:1024 sc1
    buffer_load_dwordx4 v[56:59], v201, s[36:39], s80 offen offset:2048 sc1
    buffer_load_dwordx4 v[60:63], v201, s[36:39], s80 offen offset:3072 sc1
    s_add_u32 s80, s83, 24576
    buffer_load_dwordx4 v[64:67], v201, s[36:39], s80 offen offset:0 sc1
    buffer_load_dwordx4 v[68:71], v201, s[36:39], s80 offen offset:1024 sc1
    buffer_load_dwordx4 v[72:75], v201, s[36:39], s80 offen offset:2048 sc1
    buffer_load_dwordx4 v[76:79], v201, s[36:39], s80 offen offset:3072 sc1
    s_add_u32 s74, s76, 4
    s_and_b32 s74, s74, 15
    s_lshl_b32 s74, s74, 12
    buffer_load_dwordx4 a[64:67], v2, s[28:31], s74 offen offset:0 nt
    buffer_load_dwordx4 a[68:71], v2, s[28:31], s74 offen offset:1024 nt
    buffer_load_dwordx4 a[72:75], v2, s[28:31], s74 offen offset:2048 nt
    buffer_load_dwordx4 a[76:79], v2, s[28:31], s74 offen offset:3072 nt
    s_add_u32 s75, s76, 5
    s_and_b32 s75, s75, 15
    s_lshl_b32 s75, s75, 12
    buffer_load_dwordx4 a[80:83], v2, s[28:31], s75 offen offset:0 nt
    buffer_load_dwordx4 a[84:87], v2, s[28:31], s75 offen offset:1024 nt
    buffer_load_dwordx4 a[88:91], v2, s[28:31], s75 offen offset:2048 nt
    buffer_load_dwordx4 a[92:95], v2, s[28:31], s75 offen offset:3072 nt
    s_waitcnt vmcnt(8)
    v_xor_b32 v12, v17, v196
    v_xor_b32 v13, v19, v200
    v_xor_b32 v14, v21, v196
    v_xor_b32 v15, v23, v200
    v_or_b32 v12, v12, v14
    v_or_b32 v13, v13, v15
    v_xor_b32 v14, v25, v196
    v_xor_b32 v15, v27, v200
    v_or_b32 v12, v12, v14
    v_or_b32 v13, v13, v15
    v_xor_b32 v14, v29, v196
    v_xor_b32 v15, v31, v200
    v_or_b32 v12, v12, v14
    v_or_b32 v13, v13, v15
    v_xor_b32 v14, v33, v196
    v_xor_b32 v15, v35, v200
    v_or_b32 v12, v12, v14
    v_or_b32 v13, v13, v15
    v_xor_b32 v14, v37, v196
    v_xor_b32 v15, v39, v200
    v_or_b32 v12, v12, v14
    v_or_b32 v13, v13, v15
    v_xor_b32 v14, v41, v196
    v_xor_b32 v15, v43, v200
    v_or_b32 v12, v12, v14
    v_or_b32 v13, v13, v15
    v_xor_b32 v14, v45, v196
    v_xor_b32 v15, v47, v200
    v_or_b32 v12, v12, v14
    v_or_b32 v13, v13, v15
    v_xor_b32 v14, v49, v196
    v_xor_b32 v15, v51, v200
    v_or_b32 v12, v12, v14
    v_or_b32 v13, v13, v15
    v_xor_b32 v14, v53, v196
    v_xor_b32 v15, v55, v200
    v_or_b32 v12, v12, v14
    v_or_b32 v13, v13, v15
    v_xor_b32 v14, v57, v196
    v_xor_b32 v15, v59, v200
    v_or_b32 v12, v12, v14
    v_or_b32 v13, v13, v15
    v_xor_b32 v14, v61, v196
    v_xor_b32 v15, v63, v200
    v_or_b32 v12, v12, v14
    v_or_b32 v13, v13, v15
    v_xor_b32 v14, v65, v196
    v_xor_b32 v15, v67, v200
    v_or_b32 v12, v12, v14
    v_or_b32 v13, v13, v15
    v_xor_b32 v14, v69, v196
    v_xor_b32 v15, v71, v200
    v_or_b32 v12, v12, v14
    v_or_b32 v13, v13, v15
    v_xor_b32 v14, v73, v196
    v_xor_b32 v15, v75, v200
    v_or_b32 v12, v12, v14
    v_or_b32 v13, v13, v15
    v_xor_b32 v14, v77, v196
    v_xor_b32 v15, v79, v200
    v_or_b32 v12, v12, v14
    v_or_b32 v13, v13, v15
    v_lshrrev_b32 v14, 4, v13
    v_or_b32 v12, v12, v14
    v_cmp_eq_u32 vcc, 0, v13
    s_nop 0
    s_cmp_eq_u64 vcc, -1
    s_cselect_b32 s77, 1, 0
    v_cmp_eq_u32 vcc, 0, v12
    s_nop 0
    s_cmp_eq_u64 vcc, -1
    s_cbranch_scc1 L_qok_7
    s_add_u32 s80, s83, 0
    buffer_load_dwordx4 v[16:19], v201, s[36:39], s80 offen offset:0 sc1
    buffer_load_dwordx4 v[20:23], v201, s[36:39], s80 offen offset:1024 sc1
    buffer_load_dwordx4 v[24:27], v201, s[36:39], s80 offen offset:2048 sc1
    buffer_load_dwordx4 v[28:31], v201, s[36:39], s80 offen offset:3072 sc1
    s_add_u32 s80, s83, 8192
    buffer_load_dwordx4 v[32:35], v201, s[36:39], s80 offen offset:0 sc1
    buffer_load_dwordx4 v[36:39], v201, s[36:39], s80 offen offset:1024 sc1
    buffer_load_dwordx4 v[40:43], v201, s[36:39], s80 offen offset:2048 sc1
    buffer_load_dwordx4 v[44:47], v201, s[36:39], s80 offen offset:3072 sc1
    s_add_u32 s80, s83, 16384
    buffer_load_dwordx4 v[48:51], v201, s[36:39], s80 offen offset:0 sc1
    buffer_load_dwordx4 v[52:55], v201, s[36:39], s80 offen offset:1024 sc1
    buffer_load_dwordx4 v[56:59], v201, s[36:39], s80 offen offset:2048 sc1
    buffer_load_dwordx4 v[60:63], v201, s[36:39], s80 offen offset:3072 sc1
    s_add_u32 s80, s83, 24576
    buffer_load_dwordx4 v[64:67], v201, s[36:39], s80 offen offset:0 sc1
    buffer_load_dwordx4 v[68:71], v201, s[36:39], s80 offen offset:1024 sc1
    buffer_load_dwordx4 v[72:75], v201, s[36:39], s80 offen offset:2048 sc1
    buffer_load_dwordx4 v[76:79], v201, s[36:39], s80 offen offset:3072 sc1
    s_add_u32 s74, s76, 4
    s_and_b32 s74, s74, 15
    s_lshl_b32 s74, s74, 12
    buffer_load_dwordx4 v[144:147], v3, s[32:35], s74 offen offset:0 nt
    buffer_load_dwordx4 v[148:151], v3, s[32:35], s74 offen offset:1024 nt
    buffer_load_dwordx4 v[152:155], v3, s[32:35], s74 offen offset:2048 nt
    buffer_load_dwordx4 v[156:159], v3, s[32:35], s74 offen offset:3072 nt
    s_add_u32 s75, s76, 5
    s_and_b32 s75, s75, 15
    s_lshl_b32 s75, s75, 12
    buffer_load_dwordx4 v[160:163], v3, s[32:35], s75 offen offset:0 nt
    buffer_load_dwordx4 v[164:167], v3, s[32:35], s75 offen offset:1024 nt
    buffer_load_dwordx4 v[168:171], v3, s[32:35], s75 offen offset:2048 nt
    buffer_load_dwordx4 v[172:175], v3, s[32:35], s75 offen offset:3072 nt
    s_waitcnt vmcnt(8)
    v_xor_b32 v12, v17, v196
    v_xor_b32 v13, v19, v200
    v_xor_b32 v14, v21, v196
    v_xor_b32 v15, v23, v200
    v_or_b32 v12, v12, v14
    v_or_b32 v13, v13, v15
    v_xor_b32 v14, v25, v196
    v_xor_b32 v15, v27, v200
    v_or_b32 v12, v12, v14
    v_or_b32 v13, v13, v15
    v_xor_b32 v14, v29, v196
    v_xor_b32 v15, v31, v200
    v_or_b32 v12, v12, v14
    v_or_b32 v13, v13, v15
    v_xor_b32 v14, v33, v196
    v_xor_b32 v15, v35, v200
    v_or_b32 v12, v12, v14
    v_or_b32 v13, v13, v15
    v_xor_b32 v14, v37, v196
    v_xor_b32 v15, v39, v200
    v_or_b32 v12, v12, v14
    v_or_b32 v13, v13, v15
    v_xor_b32 v14, v41, v196
    v_xor_b32 v15, v43, v200
    v_or_b32 v12, v12, v14
    v_or_b32 v13, v13, v15
    v_xor_b32 v14, v45, v196
    v_xor_b32 v15, v47, v200
    v_or_b32 v12, v12, v14
    v_or_b32 v13, v13, v15
    v_xor_b32 v14, v49, v196
    v_xor_b32 v15, v51, v200
    v_or_b32 v12, v12, v14
    v_or_b32 v13, v13, v15
    v_xor_b32 v14, v53, v196
    v_xor_b32 v15, v55, v200
    v_or_b32 v12, v12, v14
    v_or_b32 v13, v13, v15
    v_xor_b32 v14, v57, v196
    v_xor_b32 v15, v59, v200
    v_or_b32 v12, v12, v14
    v_or_b32 v13, v13, v15
    v_xor_b32 v14, v61, v196
    v_xor_b32 v15, v63, v200
    v_or_b32 v12, v12, v14
    v_or_b32 v13, v13, v15
    v_xor_b32 v14, v65, v196
    v_xor_b32 v15, v67, v200
    v_or_b32 v12, v12, v14
    v_or_b32 v13, v13, v15
    v_xor_b32 v14, v69, v196
    v_xor_b32 v15, v71, v200
    v_or_b32 v12, v12, v14
    v_or_b32 v13, v13, v15
    v_xor_b32 v14, v73, v196
    v_xor_b32 v15, v75, v200
    v_or_b32 v12, v12, v14
    v_or_b32 v13, v13, v15
    v_xor_b32 v14, v77, v196
    v_xor_b32 v15, v79, v200
    v_or_b32 v12, v12, v14
    v_or_b32 v13, v13, v15
    v_lshrrev_b32 v14, 4, v13
    v_or_b32 v12, v12, v14
    v_cmp_eq_u32 vcc, 0, v13
    s_nop 0
    s_cmp_eq_u64 vcc, -1
    s_cselect_b32 s77, 1, 0
    v_cmp_eq_u32 vcc, 0, v12
    s_nop 0
    s_cmp_eq_u64 vcc, -1
    s_cbranch_scc1 L_qok_8
    s_mov_b32 s73, 0
L_qpoll_10:
    s_add_u32 s80, s83, 0
    buffer_load_dwordx4 v[16:19], v201, s[36:39], s80 offen offset:0 sc1
    buffer_load_dwordx4 v[20:23], v201, s[36:39], s80 offen offset:1024 sc1
    buffer_load_dwordx4 v[24:27], v201, s[36:39], s80 offen offset:2048 sc1
    buffer_load_dwordx4 v[28:31], v201, s[36:39], s80 offen offset:3072 sc1
    s_add_u32 s80, s83, 8192
    buffer_load_dwordx4 v[32:35], v201, s[36:39], s80 offen offset:0 sc1
    buffer_load_dwordx4 v[36:39], v201, s[36:39], s80 offen offset:1024 sc1
    buffer_load_dwordx4 v[40:43], v201, s[36:39], s80 offen offset:2048 sc1
    buffer_load_dwordx4 v[44:47], v201, s[36:39], s80 offen offset:3072 sc1
    s_add_u32 s80, s83, 16384
    buffer_load_dwordx4 v[48:51], v201, s[36:39], s80 offen offset:0 sc1
    buffer_load_dwordx4 v[52:55], v201, s[36:39], s80 offen offset:1024 sc1
    buffer_load_dwordx4 v[56:59], v201, s[36:39], s80 offen offset:2048 sc1
    buffer_load_dwordx4 v[60:63], v201, s[36:39], s80 offen offset:3072 sc1
    s_add_u32 s80, s83, 24576
    buffer_load_dwordx4 v[64:67], v201, s[36:39], s80 offen offset:0 sc1
    buffer_load_dwordx4 v[68:71], v201, s[36:39], s80 offen offset:1024 sc1
    buffer_load_dwordx4 v[72:75], v201, s[36:39], s80 offen offset:2048 sc1
    buffer_load_dwordx4 v[76:79], v201, s[36:39], s80 offen offset:3072 sc1
    s_waitcnt vmcnt(0)
    v_xor_b32 v12, v17, v196
    v_xor_b32 v13, v19, v200
    v_xor_b32 v14, v21, v196
    v_xor_b32 v15, v23, v200
    v_or_b32 v12, v12, v14
    v_or_b32 v13, v13, v15
    v_xor_b32 v14, v25, v196
    v_xor_b32 v15, v27, v200
    v_or_b32 v12, v12, v14
    v_or_b32 v13, v13, v15
    v_xor_b32 v14, v29, v196
    v_xor_b32 v15, v31, v200
    v_or_b32 v12, v12, v14
    v_or_b32 v13, v13, v15
    v_xor_b32 v14, v33, v196
    v_xor_b32 v15, v35, v200
    v_or_b32 v12, v12, v14
    v_or_b32 v13, v13, v15
    v_xor_b32 v14, v37, v196
    v_xor_b32 v15, v39, v200
    v_or_b32 v12, v12, v14
    v_or_b32 v13, v13, v15
    v_xor_b32 v14, v41, v196
    v_xor_b32 v15, v43, v200
    v_or_b32 v12, v12, v14
    v_or_b32 v13, v13, v15
    v_xor_b32 v14, v45, v196
    v_xor_b32 v15, v47, v200
    v_or_b32 v12, v12, v14
    v_or_b32 v13, v13, v15
    v_xor_b32 v14, v49, v196
    v_xor_b32 v15, v51, v200
    v_or_b32 v12, v12, v14
    v_or_b32 v13, v13, v15
    v_xor_b32 v14, v53, v196
    v_xor_b32 v15, v55, v200
    v_or_b32 v12, v12, v14
    v_or_b32 v13, v13, v15
    v_xor_b32 v14, v57, v196
    v_xor_b32 v15, v59, v200
    v_or_b32 v12, v12, v14
    v_or_b32 v13, v13, v15
    v_xor_b32 v14, v61, v196
    v_xor_b32 v15, v63, v200
    v_or_b32 v12, v12, v14
    v_or_b32 v13, v13, v15
    v_xor_b32 v14, v65, v196
    v_xor_b32 v15, v67, v200
    v_or_b32 v12, v12, v14
    v_or_b32 v13, v13, v15
    v_xor_b32 v14, v69, v196
    v_xor_b32 v15, v71, v200
    v_or_b32 v12, v12, v14
    v_or_b32 v13, v13, v15
    v_xor_b32 v14, v73, v196
    v_xor_b32 v15, v75, v200
    v_or_b32 v12, v12, v14
    v_or_b32 v13, v13, v15
    v_xor_b32 v14, v77, v196
    v_xor_b32 v15, v79, v200
    v_or_b32 v12, v12, v14
    v_or_b32 v13, v13, v15
    v_lshrrev_b32 v14, 4, v13
    v_or_b32 v12, v12, v14
    v_cmp_eq_u32 vcc, 0, v13
    s_nop 0
    s_cmp_eq_u64 vcc, -1
    s_cselect_b32 s77, 1, 0
    v_cmp_eq_u32 vcc, 0, v12
    s_nop 0
    s_cmp_eq_u64 vcc, -1
    s_cbranch_scc1 L_qok_9
    s_add_u32 s80, s82, 0
    buffer_load_dwordx4 v[16:19], v201, s[36:39], s80 offen offset:0 sc1
    buffer_load_dwordx4 v[20:23], v201, s[36:39], s80 offen offset:1024 sc1
    buffer_load_dwordx4 v[24:27], v201, s[36:39], s80 offen offset:2048 sc1
    buffer_load_dwordx4 v[28:31], v201, s[36:39], s80 offen offset:3072 sc1
    s_add_u32 s80, s82, 8192
    buffer_load_dwordx4 v[32:35], v201, s[36:39], s80 offen offset:0 sc1
    buffer_load_dwordx4 v[36:39], v201, s[36:39], s80 offen offset:1024 sc1
    buffer_load_dwordx4 v[40:43], v201, s[36:39], s80 offen offset:2048 sc1
    buffer_load_dwordx4 v[44:47], v201, s[36:39], s80 offen offset:3072 sc1
    s_add_u32 s80, s82, 16384
    buffer_load_dwordx4 v[48:51], v201, s[36:39], s80 offen offset:0 sc1
    buffer_load_dwordx4 v[52:55], v201, s[36:39], s80 offen offset:1024 sc1
    buffer_load_dwordx4 v[56:59], v201, s[36:39], s80 offen offset:2048 sc1
    buffer_load_dwordx4 v[60:63], v201, s[36:39], s80 offen offset:3072 sc1
    s_add_u32 s80, s82, 24576
    buffer_load_dwordx4 v[64:67], v201, s[36:39], s80 offen offset:0 sc1
    buffer_load_dwordx4 v[68:71], v201, s[36:39], s80 offen offset:1024 sc1
    buffer_load_dwordx4 v[72:75], v201, s[36:39], s80 offen offset:2048 sc1
    buffer_load_dwordx4 v[76:79], v201, s[36:39], s80 offen offset:3072 sc1
    s_waitcnt vmcnt(0)
    v_xor_b32 v12, v17, v196
    v_xor_b32 v13, v19, v200
    v_xor_b32 v14, v21, v196
    v_xor_b32 v15, v23, v200
    v_or_b32 v12, v12, v14
    v_or_b32 v13, v13, v15
    v_xor_b32 v14, v25, v196
    v_xor_b32 v15, v27, v200
    v_or_b32 v12, v12, v14
    v_or_b32 v13, v13, v15
    v_xor_b32 v14, v29, v196
    v_xor_b32 v15, v31, v200
    v_or_b32 v12, v12, v14
    v_or_b32 v13, v13, v15
    v_xor_b32 v14, v33, v196
    v_xor_b32 v15, v35, v200
    v_or_b32 v12, v12, v14
    v_or_b32 v13, v13, v15
    v_xor_b32 v14, v37, v196
    v_xor_b32 v15, v39, v200
    v_or_b32 v12, v12, v14
    v_or_b32 v13, v13, v15
    v_xor_b32 v14, v41, v196
    v_xor_b32 v15, v43, v200
    v_or_b32 v12, v12, v14
    v_or_b32 v13, v13, v15
    v_xor_b32 v14, v45, v196
    v_xor_b32 v15, v47, v200
    v_or_b32 v12, v12, v14
    v_or_b32 v13, v13, v15
    v_xor_b32 v14, v49, v196
    v_xor_b32 v15, v51, v200
    v_or_b32 v12, v12, v14
    v_or_b32 v13, v13, v15
    v_xor_b32 v14, v53, v196
    v_xor_b32 v15, v55, v200
    v_or_b32 v12, v12, v14
    v_or_b32 v13, v13, v15
    v_xor_b32 v14, v57, v196
    v_xor_b32 v15, v59, v200
    v_or_b32 v12, v12, v14
    v_or_b32 v13, v13, v15
    v_xor_b32 v14, v61, v196
    v_xor_b32 v15, v63, v200
    v_or_b32 v12, v12, v14
    v_or_b32 v13, v13, v15
    v_xor_b32 v14, v65, v196
    v_xor_b32 v15, v67, v200
    v_or_b32 v12, v12, v14
    v_or_b32 v13, v13, v15
    v_xor_b32 v14, v69, v196
    v_xor_b32 v15, v71, v200
    v_or_b32 v12, v12, v14
    v_or_b32 v13, v13, v15
    v_xor_b32 v14, v73, v196
    v_xor_b32 v15, v75, v200
    v_or_b32 v12, v12, v14
    v_or_b32 v13, v13, v15
    v_xor_b32 v14, v77, v196
    v_xor_b32 v15, v79, v200
    v_or_b32 v12, v12, v14
    v_or_b32 v13, v13, v15
    v_lshrrev_b32 v14, 4, v13
    v_or_b32 v12, v12, v14
    v_cmp_eq_u32 vcc, 0, v13
    s_nop 0
    s_cmp_eq_u64 vcc, -1
    s_cselect_b32 s77, 1, 0
    v_cmp_eq_u32 vcc, 0, v12
    s_nop 0
    s_cmp_eq_u64 vcc, -1
    s_cbranch_scc1 L_qok_9
    s_add_u32 s73, s73, 1
    s_cmp_lt_u32 s73, 100000
    s_cbranch_scc1 L_qpoll_10
    s_mov_b32 s77, 2
    s_branch L_qok_9
L_qok_4:
    s_mov_b32 s81, 1
    s_branch L_qsum
L_qok_5:
    s_mov_b32 s81, 2
    s_branch L_qsum
L_qok_6:
    s_mov_b32 s81, 3
    s_branch L_qsum
L_qok_7:
    s_mov_b32 s81, 4
    s_branch L_qsum
L_qok_8:
    s_mov_b32 s81, 5
    s_branch L_qsum
L_qok_9:
    s_mov_b32 s81, 5
L_qsum:
    v_add_f32 v16, v16, v32
    v_add_f32 v48, v48, v64
    v_add_f32 v18, v18, v34
    v_add_f32 v50, v50, v66
    v_add_f32 v20, v20, v36
    v_add_f32 v52, v52, v68
    v_add_f32 v22, v22, v38
    v_add_f32 v54, v54, v70
    v_add_f32 v24, v24, v40
    v_add_f32 v56, v56, v72
    v_add_f32 v26, v26, v42
    v_add_f32 v58, v58, v74
    v_add_f32 v28, v28, v44
    v_add_f32 v60, v60, v76
    v_add_f32 v30, v30, v46
    v_add_f32 v62, v62, v78
    v_add_f32 v16, v16, v48
    v_add_f32 v18, v18, v50
    v_add_f32 v20, v20, v52
    v_add_f32 v22, v22, v54
    v_add_f32 v24, v24, v56
    v_add_f32 v26, v26, v58
    v_add_f32 v28, v28, v60
    v_add_f32 v30, v30, v62
    v_lshlrev_b32 v12, 2, v1
    v_cvt_pk_bf16_f32 v16, v16, v18
    ds_write_b32 v12, v16 offset:40960
    v_cvt_pk_bf16_f32 v20, v20, v22
    ds_write_b32 v12, v20 offset:41216
    v_cvt_pk_bf16_f32 v24, v24, v26
    ds_write_b32 v12, v24 offset:41472
    v_cvt_pk_bf16_f32 v28, v28, v30
    ds_write_b32 v12, v28 offset:41728
    v_mov_b32 v13, s77
    ds_write_b32 v12, v13 offset:41984
    s_cmp_gt_u32 s81, 1
    s_cbranch_scc1 L_rb_11
    s_add_u32 s74, s76, 2
    s_and_b32 s74, s74, 15
    s_lshl_b32 s74, s74, 12
    buffer_load_dwordx4 a[32:35], v2, s[28:31], s74 offen offset:0 nt
    buffer_load_dwordx4 a[36:39], v2, s[28:31], s74 offen offset:1024 nt
    buffer_load_dwordx4 a[40:43], v2, s[28:31], s74 offen offset:2048 nt
    buffer_load_dwordx4 a[44:47], v2, s[28:31], s74 offen offset:3072 nt
    s_add_u32 s75, s76, 3
    s_and_b32 s75, s75, 15
    s_lshl_b32 s75, s75, 12
    buffer_load_dwordx4 a[48:51], v2, s[28:31], s75 offen offset:0 nt
    buffer_load_dwordx4 a[52:55], v2, s[28:31], s75 offen offset:1024 nt
    buffer_load_dwordx4 a[56:59], v2, s[28:31], s75 offen offset:2048 nt
    buffer_load_dwordx4 a[60:63], v2, s[28:31], s75 offen offset:3072 nt
L_rb_11:
    s_cmp_gt_u32 s81, 2
    s_cbranch_scc1 L_rb_12
    s_add_u32 s74, s76, 2
    s_and_b32 s74, s74, 15
    s_lshl_b32 s74, s74, 12
    buffer_load_dwordx4 v[112:115], v3, s[32:35], s74 offen offset:0 nt
    buffer_load_dwordx4 v[116:119], v3, s[32:35], s74 offen offset:1024 nt
    buffer_load_dwordx4 v[120:123], v3, s[32:35], s74 offen offset:2048 nt
    buffer_load_dwordx4 v[124:127], v3, s[32:35], s74 offen offset:3072 nt
    s_add_u32 s75, s76, 3
    s_and_b32 s75, s75, 15
    s_lshl_b32 s75, s75, 12
    buffer_load_dwordx4 v[128:131], v3, s[32:35], s75 offen offset:0 nt
    buffer_load_dwordx4 v[132:135], v3, s[32:35], s75 offen offset:1024 nt
    buffer_load_dwordx4 v[136:139], v3, s[32:35], s75 offen offset:2048 nt
    buffer_load_dwordx4 v[140:143], v3, s[32:35], s75 offen offset:3072 nt
L_rb_12:
    s_cmp_gt_u32 s81, 3
    s_cbranch_scc1 L_rb_13
    s_add_u32 s74, s76, 4
    s_and_b32 s74, s74, 15
    s_lshl_b32 s74, s74, 12
    buffer_load_dwordx4 a[64:67], v2, s[28:31], s74 offen offset:0 nt
    buffer_load_dwordx4 a[68:71], v2, s[28:31], s74 offen offset:1024 nt
    buffer_load_dwordx4 a[72:75], v2, s[28:31], s74 offen offset:2048 nt
    buffer_load_dwordx4 a[76:79], v2, s[28:31], s74 offen offset:3072 nt
    s_add_u32 s75, s76, 5
    s_and_b32 s75, s75, 15
    s_lshl_b32 s75, s75, 12
    buffer_load_dwordx4 a[80:83], v2, s[28:31], s75 offen offset:0 nt
    buffer_load_dwordx4 a[84:87], v2, s[28:31], s75 offen offset:1024 nt
    buffer_load_dwordx4 a[88:91], v2, s[28:31], s75 offen offset:2048 nt
    buffer_load_dwordx4 a[92:95], v2, s[28:31], s75 offen offset:3072 nt
L_rb_13:
    s_cmp_gt_u32 s81, 4
    s_cbranch_scc1 L_rb_14
    s_add_u32 s74, s76, 4
    s_and_b32 s74, s74, 15
    s_lshl_b32 s74, s74, 12
    buffer_load_dwordx4 v[144:147], v3, s[32:35], s74 offen offset:0 nt
    buffer_load_dwordx4 v[148:151], v3, s[32:35], s74 offen offset:1024 nt
    buffer_load_dwordx4 v[152:155], v3, s[32:35], s74 offen offset:2048 nt
    buffer_load_dwordx4 v[156:159], v3, s[32:35], s74 offen offset:3072 nt
    s_add_u32 s75, s76, 5
    s_and_b32 s75, s75, 15
    s_lshl_b32 s75, s75, 12
    buffer_load_dwordx4 v[160:163], v3, s[32:35], s75 offen offset:0 nt
    buffer_load_dwordx4 v[164:167], v3, s[32:35], s75 offen offset:1024 nt
    buffer_load_dwordx4 v[168:171], v3, s[32:35], s75 offen offset:2048 nt
    buffer_load_dwordx4 v[172:175], v3, s[32:35], s75 offen offset:3072 nt
L_rb_14:
    s_waitcnt lgkmcnt(0)
    s_branch L_qjoin
L_helper:
    s_add_u32 s74, s76, 0
    s_and_b32 s74, s74, 15
    s_lshl_b32 s74, s74, 12
    buffer_load_dwordx4 v[80:83], v3, s[32:35], s74 offen offset:0 nt
    buffer_load_dwordx4 v[84:87], v3, s[32:35], s74 offen offset:1024 nt
    buffer_load_dwordx4 v[88:91], v3, s[32:35], s74 offen offset:2048 nt
    buffer_load_dwordx4 v[92:95], v3, s[32:35], s74 offen offset:3072 nt
    s_waitcnt vmcnt(12)
    s_add_u32 s75, s76, 1
    s_and_b32 s75, s75, 15
    s_lshl_b32 s75, s75, 12
    buffer_load_dwordx4 v[96:99], v3, s[32:35], s75 offen offset:0 nt
    buffer_load_dwordx4 v[100:103], v3, s[32:35], s75 offen offset:1024 nt
    buffer_load_dwordx4 v[104:107], v3, s[32:35], s75 offen offset:2048 nt
    buffer_load_dwordx4 v[108:111], v3, s[32:35], s75 offen offset:3072 nt
    s_waitcnt vmcnt(12)
    s_add_u32 s74, s76, 2
    s_and_b32 s74, s74, 15
    s_lshl_b32 s74, s74, 12
    buffer_load_dwordx4 a[32:35], v2, s[28:31], s74 offen offset:0 nt
    buffer_load_dwordx4 a[36:39], v2, s[28:31], s74 offen offset:1024 nt
    buffer_load_dwordx4 a[40:43], v2, s[28:31], s74 offen offset:2048 nt
    buffer_load_dwordx4 a[44:47], v2, s[28:31], s74 offen offset:3072 nt
    s_waitcnt vmcnt(12)
    s_add_u32 s75, s76, 3
    s_and_b32 s75, s75, 15
    s_lshl_b32 s75, s75, 12
    buffer_load_dwordx4 a[48:51], v2, s[28:31], s75 offen offset:0 nt
    buffer_load_dwordx4 a[52:55], v2, s[28:31], s75 offen offset:1024 nt
    buffer_load_dwordx4 a[56:59], v2, s[28:31], s75 offen offset:2048 nt
    buffer_load_dwordx4 a[60:63], v2, s[28:31], s75 offen offset:3072 nt
    s_waitcnt vmcnt(12)
    s_add_u32 s74, s76, 2
    s_and_b32 s74, s74, 15
    s_lshl_b32 s74, s74, 12
    buffer_load_dwordx4 v[112:115], v3, s[32:35], s74 offen offset:0 nt
    buffer_load_dwordx4 v[116:119], v3, s[32:35], s74 offen offset:1024 nt
    buffer_load_dwordx4 v[120:123], v3, s[32:35], s74 offen offset:2048 nt
    buffer_load_dwordx4 v[124:127], v3, s[32:35], s74 offen offset:3072 nt
    s_waitcnt vmcnt(12)
    s_add_u32 s75, s76, 3
    s_and_b32 s75, s75, 15
    s_lshl_b32 s75, s75, 12
    buffer_load_dwordx4 v[128:131], v3, s[32:35], s75 offen offset:0 nt
    buffer_load_dwordx4 v[132:135], v3, s[32:35], s75 offen offset:1024 nt
    buffer_load_dwordx4 v[136:139], v3, s[32:35], s75 offen offset:2048 nt
    buffer_load_dwordx4 v[140:143], v3, s[32:35], s75 offen offset:3072 nt
    s_waitcnt vmcnt(12)
    s_add_u32 s74, s76, 4
    s_and_b32 s74, s74, 15
    s_lshl_b32 s74, s74, 12
    buffer_load_dwordx4 a[64:67], v2, s[28:31], s74 offen offset:0 nt
    buffer_load_dwordx4 a[68:71], v2, s[28:31], s74 offen offset:1024 nt
    buffer_load_dwordx4 a[72:75], v2, s[28:31], s74 offen offset:2048 nt
    buffer_load_dwordx4 a[76:79], v2, s[28:31], s74 offen offset:3072 nt
    s_waitcnt vmcnt(12)
    s_add_u32 s75, s76, 5
    s_and_b32 s75, s75, 15
    s_lshl_b32 s75, s75, 12
    buffer_load_dwordx4 a[80:83], v2, s[28:31], s75 offen offset:0 nt
    buffer_load_dwordx4 a[84:87], v2, s[28:31], s75 offen offset:1024 nt
    buffer_load_dwordx4 a[88:91], v2, s[28:31], s75 offen offset:2048 nt
    buffer_load_dwordx4 a[92:95], v2, s[28:31], s75 offen offset:3072 nt
    s_waitcnt vmcnt(12)
    s_add_u32 s74, s76, 4
    s_and_b32 s74, s74, 15
    s_lshl_b32 s74, s74, 12
    buffer_load_dwordx4 v[144:147], v3, s[32:35], s74 offen offset:0 nt
    buffer_load_dwordx4 v[148:151], v3, s[32:35], s74 offen offset:1024 nt
    buffer_load_dwordx4 v[152:155], v3, s[32:35], s74 offen offset:2048 nt
    buffer_load_dwordx4 v[156:159], v3, s[32:35], s74 offen offset:3072 nt
    s_waitcnt vmcnt(12)
    s_add_u32 s75, s76, 5
    s_and_b32 s75, s75, 15
    s_lshl_b32 s75, s75, 12
    buffer_load_dwordx4 v[160:163], v3, s[32:35], s75 offen offset:0 nt
    buffer_load_dwordx4 v[164:167], v3, s[32:35], s75 offen offset:1024 nt
    buffer_load_dwordx4 v[168:171], v3, s[32:35], s75 offen offset:2048 nt
    buffer_load_dwordx4 v[172:175], v3, s[32:35], s75 offen offset:3072 nt
    s_waitcnt lgkmcnt(0)
    s_and_b32 s78, s60, 0xff
    s_add_u32 s79, s78, 0x35
    s_and_b32 s79, s79, 0xff
    s_lshl_b32 s79, s79, 8
    s_add_u32 s80, s78, 0x6a
    s_and_b32 s80, s80, 0xff
    s_lshl_b32 s80, s80, 16
    s_add_u32 s81, s78, 0xc1
    s_lshl_b32 s81, s81, 24
    s_or_b32 s78, s78, s79
    s_or_b32 s80, s80, s81
    s_or_b32 s78, s78, s80
    s_add_u32 s86, s60, 1
    s_mov_b32 s60, s78
    v_mov_b32 v196, s78
    s_bfe_u32 s68, s78, 0x80000
    s_bfe_u32 s69, s78, 0x80008
    s_bfe_u32 s3, s78, 0x80010
    s_bfe_u32 s27, s78, 0x80018
L_qjoin:
    v_bfe_u32 v12, v1, 2, 2
    v_lshlrev_b32 v12, 4, v12
    v_lshrrev_b32 v13, 4, v1
    v_lshl_add_u32 v12, v13, 2, v12
    v_and_b32 v13, 3, v1
    v_add_u32 v12, v12, v13
    v_lshlrev_b32 v12, 4, v12
    v_mov_b32 v13, 0
    s_barrier
    ds_read_b128 v[4:7], v12 offset:40960
    ds_read_b32 v14, v13 offset:41984
    v_mov_b32 v8, 0xff800000
    v_mov_b32 v9, 0
    v_mov_b32 v16, 0
    v_mov_b32 v17, 0
    v_mov_b32 v18, 0
    v_mov_b32 v19, 0
    v_mov_b32 v20, 0
    v_mov_b32 v21, 0
    v_mov_b32 v22, 0
    v_mov_b32 v23, 0
    v_mov_b32 v24, 0
    v_mov_b32 v25, 0
    v_mov_b32 v26, 0
    v_mov_b32 v27, 0
    v_mov_b32 v28, 0
    v_mov_b32 v29, 0
    v_mov_b32 v30, 0
    v_mov_b32 v31, 0
    v_mov_b32 v32, 0
    v_mov_b32 v33, 0
    v_mov_b32 v34, 0
    v_mov_b32 v35, 0
    v_mov_b32 v36, 0
    v_mov_b32 v37, 0
    v_mov_b32 v38, 0
    v_mov_b32 v39, 0
    v_mov_b32 v40, 0
    v_mov_b32 v41, 0
    v_mov_b32 v42, 0
    v_mov_b32 v43, 0
    v_mov_b32 v44, 0
    v_mov_b32 v45, 0
    v_mov_b32 v46, 0
    v_mov_b32 v47, 0
    s_waitcnt lgkmcnt(0)
    v_readfirstlane_b32 s77, v14
    s_nop 0
    s_cmp_eq_u32 s77, 2
    s_cbranch_scc1 L_fail
    s_cmp_lg_u32 s58, 0
    s_cbranch_scc1 L_nw0_15
L_nw0_15:
    s_lshl_b32 s78, s56, 19
    s_lshr_b32 s79, s57, 1
    s_lshl_b32 s79, s79, 15
    s_add_u32 s78, s78, s79
    s_and_b32 s79, s57, 1
    s_lshl_b32 s79, s79, 9
    s_add_u32 s78, s78, s79
    s_sub_u32 s80, 0x8000, s79
    s_cmp_lt_u32 s58, 2
    s_cselect_b32 s79, s80, 0
    s_add_u32 s40, s12, s78
    s_addc_u32 s41, s13, 0
    s_mov_b32 s42, 0x0
    s_mov_b32 s43, 0x20000
    s_mov_b32 s42, s79
    v_lshrrev_b32 v12, 4, v1
    v_lshlrev_b32 v254, 13, v12
    v_and_b32 v12, 15, v1
    v_lshl_add_u32 v254, v12, 4, v254
    s_and_b32 s78, s58, 1
    s_lshl_b32 s78, s78, 8
    v_add_u32 v254, s78, v254
    v_bfe_u32 v12, v1, 2, 2
    v_lshlrev_b32 v242, 9, v12
    v_lshrrev_b32 v13, 4, v1
    v_lshl_add_u32 v242, v13, 7, v242
    s_lshl_b32 s78, s58, 11
    v_add_u32 v242, s78, v242
    v_lshlrev_b32 v244, 4, v12
    s_lshl_b32 s78, s58, 2
    v_add_u32 v243, s78, v244
    v_lshlrev_b32 v245, 4, v0
    v_lshrrev_b32 v13, 5, v0
    v_lshlrev_b32 v246, 4, v13
    s_lshl_b32 s14, s87, 11
    s_add_u32 s14, s14, 65536
    s_lshl_b32 s15, s87, 7
    s_add_u32 s15, s15, 589824
    v_lshrrev_b32 v12, 3, v1
    v_lshlrev_b32 v230, 11, v12
    v_and_b32 v13, 7, v1
    v_lshl_add_u32 v230, v13, 4, v230
    v_lshlrev_b32 v231, 7, v12
    v_lshrrev_b32 v12, 4, v1
    v_lshlrev_b32 v232, 4, v12
    v_lshl_add_u32 v232, v13, 1, v232
    s_and_b32 s78, s58, 1
    s_lshl_b32 s78, s78, 6
    v_add_u32 v232, s78, v232
    v_bfe_u32 v13, v1, 2, 1
    v_lshlrev_b32 v13, 6, v13
    v_lshl_add_u32 v233, v12, 4, v13
    v_and_b32 v13, 15, v1
    v_lshlrev_b32 v235, 12, v12
    v_lshl_add_u32 v235, v13, 4, v235
    v_lshlrev_b32 v236, 2, v12
    v_lshl_add_u32 v236, v13, 4, v236
    v_or_b32 v237, 0x07060500, v12
    v_lshlrev_b32 v234, 6, v13
    v_bfe_u32 v13, v1, 5, 1
    v_lshl_add_u32 v234, v13, 5, v234
    v_bfe_u32 v13, v1, 4, 1
    v_lshl_add_u32 v234, v13, 4, v234
    s_and_b32 s78, s57, 1
    s_lshl_b32 s78, s78, 1
    s_and_b32 s79, s58, 1
    s_add_u32 s78, s78, s79
    s_lshl_b32 s78, s78, 10
    v_add_u32 v234, s78, v234
    s_lshr_b32 s81, s57, 1
    s_lshl_b32 s8, s56, 4
    s_add_u32 s8, s8, s81
    s_lshl_b32 s8, s8, 12
    s_add_u32 s8, s8, 655360
    s_lshl_b32 s78, s56, 5
    s_and_b32 s79, s58, 1
    s_lshl_b32 s79, s79, 4
    s_add_u32 s78, s78, s79
    s_lshl_b32 s79, s78, 11
    s_lshl_b32 s80, s81, 7
    s_add_u32 s79, s79, s80
    s_add_u32 s4, s79, 65536
    s_add_u32 s5, s4, 16384
    s_lshl_b32 s80, s78, 7
    s_lshr_b32 s81, s81, 2
    s_lshl_b32 s81, s81, 4
    s_add_u32 s80, s80, s81
    s_add_u32 s6, s80, 589824
    s_add_u32 s7, s6, 1024
    s_lshr_b32 s78, s56, 1
    s_and_b32 s79, s56, 1
    s_cmp_eq_u32 s79, 0
    s_cselect_b32 s79, 28, 32
    s_mul_i32 s9, s78, s79
    s_add_u32 s9, s9, s57
    s_sub_u32 s79, s57, 28
    s_lshl_b32 s79, s79, 2
    s_add_u32 s79, s79, s58
    s_and_b32 s79, s79, 15
    s_lshl_b32 s79, s79, 8
    s_lshl_b32 s78, s56, 16
    s_add_u32 s78, s78, s79
    s_add_u32 s10, s78, 655360
    s_add_u32 s11, s10, 16384
    s_add_u32 s12, s10, 32768
    s_add_u32 s13, s10, 49152
    s_lshl_b32 s78, s56, 12
    s_add_u32 s78, s78, s79
    s_add_u32 s26, s78, 1179648
    v_and_b32 v12, 15, v1
    v_lshlrev_b32 v13, 11, v12
    v_add_u32 v13, s4, v13
    v_lshlrev_b32 v238, 7, v12
    v_add_u32 v238, s6, v238
    s_mov_b32 s84, 0xffff0000
    s_mov_b32 s85, 0
    v_cndmask_b32 v238, v13, v238, s[84:85]
    s_cmp_lt_u32 s58, 2
    s_cselect_b32 s78, 0, 0x7ff00000
    v_add_u32 v238, s78, v238
    v_bfe_u32 v12, v1, 1, 4
    v_lshlrev_b32 v12, 12, v12
    v_and_b32 v13, 1, v1
    v_lshl_add_u32 v12, v13, 7, v12
    v_add_u32 v12, s10, v12
    s_cmp_ge_u32 s57, 28
    s_cselect_b32 s78, 0, 0x7ff00000
    v_add_u32 v12, s78, v12
    s_mov_b32 s84, 0
    s_mov_b32 s85, -1
    v_cndmask_b32 v238, v238, v12, s[84:85]
    s_mov_b32 s80, 4096
    s_mov_b32 s81, 0
    s_add_u32 s74, s76, 6
    s_add_u32 s75, s76, 7
    s_and_b32 s74, s74, 15
    s_and_b32 s75, s75, 15
    s_lshl_b32 s74, s74, 12
    s_lshl_b32 s75, s75, 12
    s_waitcnt vmcnt(47)
    v_mfma_f32_16x16x32_bf16 v[48:51], a[0:3], v[4:7], 0
    buffer_load_dwordx4 a[0:3], v2, s[28:31], s74 offen offset:0 nt
    s_waitcnt vmcnt(47)
    v_mfma_f32_16x16x32_bf16 v[52:55], a[4:7], v[4:7], 0
    buffer_load_dwordx4 a[4:7], v2, s[28:31], s74 offen offset:1024 nt
    s_waitcnt vmcnt(47)
    v_mfma_f32_16x16x32_bf16 v[56:59], a[8:11], v[4:7], 0
    buffer_load_dwordx4 a[8:11], v2, s[28:31], s74 offen offset:2048 nt
    s_waitcnt vmcnt(47)
    v_mfma_f32_16x16x32_bf16 v[60:63], a[12:15], v[4:7], 0
    buffer_load_dwordx4 a[12:15], v2, s[28:31], s74 offen offset:3072 nt
    s_waitcnt vmcnt(47)
    v_mfma_f32_16x16x32_bf16 v[64:67], a[16:19], v[4:7], 0
    buffer_load_dwordx4 a[16:19], v2, s[28:31], s75 offen offset:0 nt
    s_waitcnt vmcnt(47)
    v_mfma_f32_16x16x32_bf16 v[68:71], a[20:23], v[4:7], 0
    buffer_load_dwordx4 a[20:23], v2, s[28:31], s75 offen offset:1024 nt
    s_waitcnt vmcnt(47)
    v_mfma_f32_16x16x32_bf16 v[72:75], a[24:27], v[4:7], 0
    buffer_load_dwordx4 a[24:27], v2, s[28:31], s75 offen offset:2048 nt
    s_waitcnt vmcnt(47)
    v_mfma_f32_16x16x32_bf16 v[76:79], a[28:31], v[4:7], 0
    buffer_load_dwordx4 a[28:31], v2, s[28:31], s75 offen offset:3072 nt
    v_mov_b32_dpp v176, v48 quad_perm:[0,0,0,0] row_mask:0xf bank_mask:0xf
    v_mov_b32_dpp v177, v52 quad_perm:[0,0,0,0] row_mask:0xf bank_mask:0xf
    v_mov_b32_dpp v178, v56 quad_perm:[0,0,0,0] row_mask:0xf bank_mask:0xf
    v_mov_b32_dpp v179, v60 quad_perm:[0,0,0,0] row_mask:0xf bank_mask:0xf
    v_mov_b32_dpp v180, v64 quad_perm:[0,0,0,0] row_mask:0xf bank_mask:0xf
    v_mov_b32_dpp v181, v68 quad_perm:[0,0,0,0] row_mask:0xf bank_mask:0xf
    v_mov_b32_dpp v182, v72 quad_perm:[0,0,0,0] row_mask:0xf bank_mask:0xf
    v_mov_b32_dpp v183, v76 quad_perm:[0,0,0,0] row_mask:0xf bank_mask:0xf
    v_add_f32_dpp v176, v49, v176 quad_perm:[1,1,1,1] row_mask:0xf bank_mask:0xf
    v_add_f32_dpp v177, v53, v177 quad_perm:[1,1,1,1] row_mask:0xf bank_mask:0xf
    v_add_f32_dpp v178, v57, v178 quad_perm:[1,1,1,1] row_mask:0xf bank_mask:0xf
    v_add_f32_dpp v179, v61, v179 quad_perm:[1,1,1,1] row_mask:0xf bank_mask:0xf
    v_add_f32_dpp v180, v65, v180 quad_perm:[1,1,1,1] row_mask:0xf bank_mask:0xf
    v_add_f32_dpp v181, v69, v181 quad_perm:[1,1,1,1] row_mask:0xf bank_mask:0xf
    v_add_f32_dpp v182, v73, v182 quad_perm:[1,1,1,1] row_mask:0xf bank_mask:0xf
    v_add_f32_dpp v183, v77, v183 quad_perm:[1,1,1,1] row_mask:0xf bank_mask:0xf
    v_add_f32_dpp v176, v50, v176 quad_perm:[2,2,2,2] row_mask:0xf bank_mask:0xf
    v_add_f32_dpp v177, v54, v177 quad_perm:[2,2,2,2] row_mask:0xf bank_mask:0xf
    v_add_f32_dpp v178, v58, v178 quad_perm:[2,2,2,2] row_mask:0xf bank_mask:0xf
    v_add_f32_dpp v179, v62, v179 quad_perm:[2,2,2,2] row_mask:0xf bank_mask:0xf
    v_add_f32_dpp v180, v66, v180 quad_perm:[2,2,2,2] row_mask:0xf bank_mask:0xf
    v_add_f32_dpp v181, v70, v181 quad_perm:[2,2,2,2] row_mask:0xf bank_mask:0xf
    v_add_f32_dpp v182, v74, v182 quad_perm:[2,2,2,2] row_mask:0xf bank_mask:0xf
    v_add_f32_dpp v183, v78, v183 quad_perm:[2,2,2,2] row_mask:0xf bank_mask:0xf
    v_add_f32_dpp v176, v51, v176 quad_perm:[3,3,3,3] row_mask:0xf bank_mask:0xf
    v_add_f32_dpp v177, v55, v177 quad_perm:[3,3,3,3] row_mask:0xf bank_mask:0xf
    v_add_f32_dpp v178, v59, v178 quad_perm:[3,3,3,3] row_mask:0xf bank_mask:0xf
    v_add_f32_dpp v179, v63, v179 quad_perm:[3,3,3,3] row_mask:0xf bank_mask:0xf
    v_add_f32_dpp v180, v67, v180 quad_perm:[3,3,3,3] row_mask:0xf bank_mask:0xf
    v_add_f32_dpp v181, v71, v181 quad_perm:[3,3,3,3] row_mask:0xf bank_mask:0xf
    v_add_f32_dpp v182, v75, v182 quad_perm:[3,3,3,3] row_mask:0xf bank_mask:0xf
    v_add_f32_dpp v183, v79, v183 quad_perm:[3,3,3,3] row_mask:0xf bank_mask:0xf
    v_cvt_pk_bf16_f32 v192, v176, v177
    v_cvt_pk_bf16_f32 v193, v178, v179
    v_cvt_pk_bf16_f32 v194, v180, v181
    v_cvt_pk_bf16_f32 v195, v182, v183
    v_lshlrev_b32 v184, 16, v192
    v_and_b32 v185, 0xffff0000, v192
    v_lshlrev_b32 v186, 16, v193
    v_and_b32 v187, 0xffff0000, v193
    v_lshlrev_b32 v188, 16, v194
    v_and_b32 v189, 0xffff0000, v194
    v_lshlrev_b32 v190, 16, v195
    v_and_b32 v191, 0xffff0000, v195
    v_pk_mul_f32 v[184:185], v[184:185], s[70:71]
    v_pk_mul_f32 v[186:187], v[186:187], s[70:71]
    v_pk_mul_f32 v[188:189], v[188:189], s[70:71]
    v_pk_mul_f32 v[190:191], v[190:191], s[70:71]
    v_cvt_pk_bf16_f32 v192, v184, v185
    v_cvt_pk_bf16_f32 v193, v186, v187
    v_cvt_pk_bf16_f32 v194, v188, v189
    v_cvt_pk_bf16_f32 v195, v190, v191
    v_lshlrev_b32 v176, 16, v192
    v_and_b32 v177, 0xffff0000, v192
    v_lshlrev_b32 v178, 16, v193
    v_and_b32 v179, 0xffff0000, v193
    v_lshlrev_b32 v180, 16, v194
    v_and_b32 v181, 0xffff0000, v194
    v_lshlrev_b32 v182, 16, v195
    v_and_b32 v183, 0xffff0000, v195
    v_max3_f32 v12, v176, v177, v178
    v_max3_f32 v13, v179, v180, v181
    v_max3_f32 v12, v12, v182, v183
    v_max_f32 v12, v12, v13
    v_mov_b32 v13, v12
    s_nop 1
    v_permlane16_swap_b32 v12, v13
    v_max_f32 v12, v12, v13
    v_mov_b32 v13, v12
    s_nop 1
    v_permlane32_swap_b32 v12, v13
    v_max_f32 v12, v12, v13
    v_max_f32 v12, v12, v8
    v_sub_f32 v10, v8, v12
    v_mul_f32 v10, s72, v10
    v_mov_b32 v8, v12
    v_mul_f32 v13, s72, v12
    v_exp_f32 v10, v10
    v_fma_f32 v184, v176, s72, -v13
    v_fma_f32 v185, v177, s72, -v13
    v_fma_f32 v186, v178, s72, -v13
    v_fma_f32 v187, v179, s72, -v13
    v_fma_f32 v188, v180, s72, -v13
    v_fma_f32 v189, v181, s72, -v13
    v_fma_f32 v190, v182, s72, -v13
    v_fma_f32 v191, v183, s72, -v13
    v_exp_f32 v184, v184
    v_exp_f32 v185, v185
    v_exp_f32 v186, v186
    v_exp_f32 v187, v187
    v_exp_f32 v188, v188
    v_exp_f32 v189, v189
    v_exp_f32 v190, v190
    v_exp_f32 v191, v191
    v_cvt_pk_bf16_f32 v192, v184, v185
    v_cvt_pk_bf16_f32 v193, v186, v187
    v_cvt_pk_bf16_f32 v194, v188, v189
    v_cvt_pk_bf16_f32 v195, v190, v191
    v_pk_add_f32 v[184:185], v[184:185], v[186:187]
    v_pk_add_f32 v[188:189], v[188:189], v[190:191]
    v_pk_add_f32 v[184:185], v[184:185], v[188:189]
    v_fma_f32 v9, v9, v10, v184
    v_add_f32 v9, v9, v185
    v_pk_mul_f32 v[16:17], v[16:17], v[10:11] op_sel_hi:[1,0]
    v_pk_mul_f32 v[18:19], v[18:19], v[10:11] op_sel_hi:[1,0]
    v_pk_mul_f32 v[20:21], v[20:21], v[10:11] op_sel_hi:[1,0]
    v_pk_mul_f32 v[22:23], v[22:23], v[10:11] op_sel_hi:[1,0]
    v_pk_mul_f32 v[24:25], v[24:25], v[10:11] op_sel_hi:[1,0]
    v_pk_mul_f32 v[26:27], v[26:27], v[10:11] op_sel_hi:[1,0]
    v_pk_mul_f32 v[28:29], v[28:29], v[10:11] op_sel_hi:[1,0]
    v_pk_mul_f32 v[30:31], v[30:31], v[10:11] op_sel_hi:[1,0]
    v_pk_mul_f32 v[32:33], v[32:33], v[10:11] op_sel_hi:[1,0]
    v_pk_mul_f32 v[34:35], v[34:35], v[10:11] op_sel_hi:[1,0]
    v_pk_mul_f32 v[36:37], v[36:37], v[10:11] op_sel_hi:[1,0]
    v_pk_mul_f32 v[38:39], v[38:39], v[10:11] op_sel_hi:[1,0]
    v_pk_mul_f32 v[40:41], v[40:41], v[10:11] op_sel_hi:[1,0]
    v_pk_mul_f32 v[42:43], v[42:43], v[10:11] op_sel_hi:[1,0]
    v_pk_mul_f32 v[44:45], v[44:45], v[10:11] op_sel_hi:[1,0]
    v_pk_mul_f32 v[46:47], v[46:47], v[10:11] op_sel_hi:[1,0]
    s_waitcnt vmcnt(46)
    v_perm_b32 v48, v84, v80, s62
    v_perm_b32 v52, v84, v80, s63
    v_perm_b32 v56, v85, v81, s62
    v_perm_b32 v60, v85, v81, s63
    v_perm_b32 v64, v86, v82, s62
    v_perm_b32 v68, v86, v82, s63
    v_perm_b32 v72, v87, v83, s62
    v_perm_b32 v76, v87, v83, s63
    buffer_load_dwordx4 v[80:83], v3, s[32:35], s74 offen offset:0 nt
    buffer_load_dwordx4 v[84:87], v3, s[32:35], s74 offen offset:1024 nt
    s_waitcnt vmcnt(46)
    v_perm_b32 v49, v92, v88, s62
    v_perm_b32 v53, v92, v88, s63
    v_perm_b32 v57, v93, v89, s62
    v_perm_b32 v61, v93, v89, s63
    v_perm_b32 v65, v94, v90, s62
    v_perm_b32 v69, v94, v90, s63
    v_perm_b32 v73, v95, v91, s62
    v_perm_b32 v77, v95, v91, s63
    buffer_load_dwordx4 v[88:91], v3, s[32:35], s74 offen offset:2048 nt
    buffer_load_dwordx4 v[92:95], v3, s[32:35], s74 offen offset:3072 nt
    s_waitcnt vmcnt(46)
    v_perm_b32 v50, v100, v96, s62
    v_perm_b32 v54, v100, v96, s63
    v_perm_b32 v58, v101, v97, s62
    v_perm_b32 v62, v101, v97, s63
    v_perm_b32 v66, v102, v98, s62
    v_perm_b32 v70, v102, v98, s63
    v_perm_b32 v74, v103, v99, s62
    v_perm_b32 v78, v103, v99, s63
    buffer_load_dwordx4 v[96:99], v3, s[32:35], s75 offen offset:0 nt
    buffer_load_dwordx4 v[100:103], v3, s[32:35], s75 offen offset:1024 nt
    s_waitcnt vmcnt(46)
    v_perm_b32 v51, v108, v104, s62
    v_perm_b32 v55, v108, v104, s63
    v_perm_b32 v59, v109, v105, s62
    v_perm_b32 v63, v109, v105, s63
    v_perm_b32 v67, v110, v106, s62
    v_perm_b32 v71, v110, v106, s63
    v_perm_b32 v75, v111, v107, s62
    v_perm_b32 v79, v111, v107, s63
    buffer_load_dwordx4 v[104:107], v3, s[32:35], s75 offen offset:2048 nt
    buffer_load_dwordx4 v[108:111], v3, s[32:35], s75 offen offset:3072 nt
    v_mfma_f32_16x16x32_bf16 v[16:19], v[48:51], v[192:195], v[16:19]
    v_mfma_f32_16x16x32_bf16 v[20:23], v[52:55], v[192:195], v[20:23]
    v_mfma_f32_16x16x32_bf16 v[24:27], v[56:59], v[192:195], v[24:27]
    v_mfma_f32_16x16x32_bf16 v[28:31], v[60:63], v[192:195], v[28:31]
    v_mfma_f32_16x16x32_bf16 v[32:35], v[64:67], v[192:195], v[32:35]
    v_mfma_f32_16x16x32_bf16 v[36:39], v[68:71], v[192:195], v[36:39]
    v_mfma_f32_16x16x32_bf16 v[40:43], v[72:75], v[192:195], v[40:43]
    v_mfma_f32_16x16x32_bf16 v[44:47], v[76:79], v[192:195], v[44:47]
    s_add_u32 s74, s76, 8
    s_add_u32 s75, s76, 9
    s_and_b32 s74, s74, 15
    s_and_b32 s75, s75, 15
    s_lshl_b32 s74, s74, 12
    s_lshl_b32 s75, s75, 12
    s_waitcnt vmcnt(47)
    v_mfma_f32_16x16x32_bf16 v[48:51], a[32:35], v[4:7], 0
    buffer_load_dwordx4 a[32:35], v2, s[28:31], s74 offen offset:0 nt
    s_waitcnt vmcnt(47)
    v_mfma_f32_16x16x32_bf16 v[52:55], a[36:39], v[4:7], 0
    buffer_load_dwordx4 a[36:39], v2, s[28:31], s74 offen offset:1024 nt
    s_waitcnt vmcnt(47)
    v_mfma_f32_16x16x32_bf16 v[56:59], a[40:43], v[4:7], 0
    buffer_load_dwordx4 a[40:43], v2, s[28:31], s74 offen offset:2048 nt
    s_waitcnt vmcnt(47)
    v_mfma_f32_16x16x32_bf16 v[60:63], a[44:47], v[4:7], 0
    buffer_load_dwordx4 a[44:47], v2, s[28:31], s74 offen offset:3072 nt
    s_waitcnt vmcnt(47)
    v_mfma_f32_16x16x32_bf16 v[64:67], a[48:51], v[4:7], 0
    buffer_load_dwordx4 a[48:51], v2, s[28:31], s75 offen offset:0 nt
    s_waitcnt vmcnt(47)
    v_mfma_f32_16x16x32_bf16 v[68:71], a[52:55], v[4:7], 0
    buffer_load_dwordx4 a[52:55], v2, s[28:31], s75 offen offset:1024 nt
    s_waitcnt vmcnt(47)
    v_mfma_f32_16x16x32_bf16 v[72:75], a[56:59], v[4:7], 0
    buffer_load_dwordx4 a[56:59], v2, s[28:31], s75 offen offset:2048 nt
    s_waitcnt vmcnt(47)
    v_mfma_f32_16x16x32_bf16 v[76:79], a[60:63], v[4:7], 0
    buffer_load_dwordx4 a[60:63], v2, s[28:31], s75 offen offset:3072 nt
    v_mov_b32_dpp v176, v48 quad_perm:[0,0,0,0] row_mask:0xf bank_mask:0xf
    v_mov_b32_dpp v177, v52 quad_perm:[0,0,0,0] row_mask:0xf bank_mask:0xf
    v_mov_b32_dpp v178, v56 quad_perm:[0,0,0,0] row_mask:0xf bank_mask:0xf
    v_mov_b32_dpp v179, v60 quad_perm:[0,0,0,0] row_mask:0xf bank_mask:0xf
    v_mov_b32_dpp v180, v64 quad_perm:[0,0,0,0] row_mask:0xf bank_mask:0xf
    v_mov_b32_dpp v181, v68 quad_perm:[0,0,0,0] row_mask:0xf bank_mask:0xf
    v_mov_b32_dpp v182, v72 quad_perm:[0,0,0,0] row_mask:0xf bank_mask:0xf
    v_mov_b32_dpp v183, v76 quad_perm:[0,0,0,0] row_mask:0xf bank_mask:0xf
    v_add_f32_dpp v176, v49, v176 quad_perm:[1,1,1,1] row_mask:0xf bank_mask:0xf
    v_add_f32_dpp v177, v53, v177 quad_perm:[1,1,1,1] row_mask:0xf bank_mask:0xf
    v_add_f32_dpp v178, v57, v178 quad_perm:[1,1,1,1] row_mask:0xf bank_mask:0xf
    v_add_f32_dpp v179, v61, v179 quad_perm:[1,1,1,1] row_mask:0xf bank_mask:0xf
    v_add_f32_dpp v180, v65, v180 quad_perm:[1,1,1,1] row_mask:0xf bank_mask:0xf
    v_add_f32_dpp v181, v69, v181 quad_perm:[1,1,1,1] row_mask:0xf bank_mask:0xf
    v_add_f32_dpp v182, v73, v182 quad_perm:[1,1,1,1] row_mask:0xf bank_mask:0xf
    v_add_f32_dpp v183, v77, v183 quad_perm:[1,1,1,1] row_mask:0xf bank_mask:0xf
    v_add_f32_dpp v176, v50, v176 quad_perm:[2,2,2,2] row_mask:0xf bank_mask:0xf
    v_add_f32_dpp v177, v54, v177 quad_perm:[2,2,2,2] row_mask:0xf bank_mask:0xf
    v_add_f32_dpp v178, v58, v178 quad_perm:[2,2,2,2] row_mask:0xf bank_mask:0xf
    v_add_f32_dpp v179, v62, v179 quad_perm:[2,2,2,2] row_mask:0xf bank_mask:0xf
    v_add_f32_dpp v180, v66, v180 quad_perm:[2,2,2,2] row_mask:0xf bank_mask:0xf
    v_add_f32_dpp v181, v70, v181 quad_perm:[2,2,2,2] row_mask:0xf bank_mask:0xf
    v_add_f32_dpp v182, v74, v182 quad_perm:[2,2,2,2] row_mask:0xf bank_mask:0xf
    v_add_f32_dpp v183, v78, v183 quad_perm:[2,2,2,2] row_mask:0xf bank_mask:0xf
    v_add_f32_dpp v176, v51, v176 quad_perm:[3,3,3,3] row_mask:0xf bank_mask:0xf
    v_add_f32_dpp v177, v55, v177 quad_perm:[3,3,3,3] row_mask:0xf bank_mask:0xf
    v_add_f32_dpp v178, v59, v178 quad_perm:[3,3,3,3] row_mask:0xf bank_mask:0xf
    v_add_f32_dpp v179, v63, v179 quad_perm:[3,3,3,3] row_mask:0xf bank_mask:0xf
    v_add_f32_dpp v180, v67, v180 quad_perm:[3,3,3,3] row_mask:0xf bank_mask:0xf
    v_add_f32_dpp v181, v71, v181 quad_perm:[3,3,3,3] row_mask:0xf bank_mask:0xf
    v_add_f32_dpp v182, v75, v182 quad_perm:[3,3,3,3] row_mask:0xf bank_mask:0xf
    v_add_f32_dpp v183, v79, v183 quad_perm:[3,3,3,3] row_mask:0xf bank_mask:0xf
    v_cvt_pk_bf16_f32 v192, v176, v177
    v_cvt_pk_bf16_f32 v193, v178, v179
    v_cvt_pk_bf16_f32 v194, v180, v181
    v_cvt_pk_bf16_f32 v195, v182, v183
    v_lshlrev_b32 v184, 16, v192
    v_and_b32 v185, 0xffff0000, v192
    v_lshlrev_b32 v186, 16, v193
    v_and_b32 v187, 0xffff0000, v193
    v_lshlrev_b32 v188, 16, v194
    v_and_b32 v189, 0xffff0000, v194
    v_lshlrev_b32 v190, 16, v195
    v_and_b32 v191, 0xffff0000, v195
    v_pk_mul_f32 v[184:185], v[184:185], s[70:71]
    v_pk_mul_f32 v[186:187], v[186:187], s[70:71]
    v_pk_mul_f32 v[188:189], v[188:189], s[70:71]
    v_pk_mul_f32 v[190:191], v[190:191], s[70:71]
    v_cvt_pk_bf16_f32 v192, v184, v185
    v_cvt_pk_bf16_f32 v193, v186, v187
    v_cvt_pk_bf16_f32 v194, v188, v189
    v_cvt_pk_bf16_f32 v195, v190, v191
    v_lshlrev_b32 v176, 16, v192
    v_and_b32 v177, 0xffff0000, v192
    v_lshlrev_b32 v178, 16, v193
    v_and_b32 v179, 0xffff0000, v193
    v_lshlrev_b32 v180, 16, v194
    v_and_b32 v181, 0xffff0000, v194
    v_lshlrev_b32 v182, 16, v195
    v_and_b32 v183, 0xffff0000, v195
    v_max3_f32 v12, v176, v177, v178
    v_max3_f32 v13, v179, v180, v181
    v_max3_f32 v12, v12, v182, v183
    v_max_f32 v12, v12, v13
    v_mov_b32 v13, v12
    s_nop 1
    v_permlane16_swap_b32 v12, v13
    v_max_f32 v12, v12, v13
    v_mov_b32 v13, v12
    s_nop 1
    v_permlane32_swap_b32 v12, v13
    v_max_f32 v12, v12, v13
    v_max_f32 v12, v12, v8
    v_sub_f32 v10, v8, v12
    v_mul_f32 v10, s72, v10
    v_mov_b32 v8, v12
    v_mul_f32 v13, s72, v12
    v_exp_f32 v10, v10
    v_fma_f32 v184, v176, s72, -v13
    v_fma_f32 v185, v177, s72, -v13
    v_fma_f32 v186, v178, s72, -v13
    v_fma_f32 v187, v179, s72, -v13
    v_fma_f32 v188, v180, s72, -v13
    v_fma_f32 v189, v181, s72, -v13
    v_fma_f32 v190, v182, s72, -v13
    v_fma_f32 v191, v183, s72, -v13
    v_exp_f32 v184, v184
    v_exp_f32 v185, v185
    v_exp_f32 v186, v186
    v_exp_f32 v187, v187
    v_exp_f32 v188, v188
    v_exp_f32 v189, v189
    v_exp_f32 v190, v190
    v_exp_f32 v191, v191
    v_cvt_pk_bf16_f32 v192, v184, v185
    v_cvt_pk_bf16_f32 v193, v186, v187
    v_cvt_pk_bf16_f32 v194, v188, v189
    v_cvt_pk_bf16_f32 v195, v190, v191
    v_pk_add_f32 v[184:185], v[184:185], v[186:187]
    v_pk_add_f32 v[188:189], v[188:189], v[190:191]
    v_pk_add_f32 v[184:185], v[184:185], v[188:189]
    v_fma_f32 v9, v9, v10, v184
    v_add_f32 v9, v9, v185
    v_pk_mul_f32 v[16:17], v[16:17], v[10:11] op_sel_hi:[1,0]
    v_pk_mul_f32 v[18:19], v[18:19], v[10:11] op_sel_hi:[1,0]
    v_pk_mul_f32 v[20:21], v[20:21], v[10:11] op_sel_hi:[1,0]
    v_pk_mul_f32 v[22:23], v[22:23], v[10:11] op_sel_hi:[1,0]
    v_pk_mul_f32 v[24:25], v[24:25], v[10:11] op_sel_hi:[1,0]
    v_pk_mul_f32 v[26:27], v[26:27], v[10:11] op_sel_hi:[1,0]
    v_pk_mul_f32 v[28:29], v[28:29], v[10:11] op_sel_hi:[1,0]
    v_pk_mul_f32 v[30:31], v[30:31], v[10:11] op_sel_hi:[1,0]
    v_pk_mul_f32 v[32:33], v[32:33], v[10:11] op_sel_hi:[1,0]
    v_pk_mul_f32 v[34:35], v[34:35], v[10:11] op_sel_hi:[1,0]
    v_pk_mul_f32 v[36:37], v[36:37], v[10:11] op_sel_hi:[1,0]
    v_pk_mul_f32 v[38:39], v[38:39], v[10:11] op_sel_hi:[1,0]
    v_pk_mul_f32 v[40:41], v[40:41], v[10:11] op_sel_hi:[1,0]
    v_pk_mul_f32 v[42:43], v[42:43], v[10:11] op_sel_hi:[1,0]
    v_pk_mul_f32 v[44:45], v[44:45], v[10:11] op_sel_hi:[1,0]
    v_pk_mul_f32 v[46:47], v[46:47], v[10:11] op_sel_hi:[1,0]
    s_waitcnt vmcnt(46)
    v_perm_b32 v48, v116, v112, s62
    v_perm_b32 v52, v116, v112, s63
    v_perm_b32 v56, v117, v113, s62
    v_perm_b32 v60, v117, v113, s63
    v_perm_b32 v64, v118, v114, s62
    v_perm_b32 v68, v118, v114, s63
    v_perm_b32 v72, v119, v115, s62
    v_perm_b32 v76, v119, v115, s63
    buffer_load_dwordx4 v[112:115], v3, s[32:35], s74 offen offset:0 nt
    buffer_load_dwordx4 v[116:119], v3, s[32:35], s74 offen offset:1024 nt
    s_waitcnt vmcnt(46)
    v_perm_b32 v49, v124, v120, s62
    v_perm_b32 v53, v124, v120, s63
    v_perm_b32 v57, v125, v121, s62
    v_perm_b32 v61, v125, v121, s63
    v_perm_b32 v65, v126, v122, s62
    v_perm_b32 v69, v126, v122, s63
    v_perm_b32 v73, v127, v123, s62
    v_perm_b32 v77, v127, v123, s63
    buffer_load_dwordx4 v[120:123], v3, s[32:35], s74 offen offset:2048 nt
    buffer_load_dwordx4 v[124:127], v3, s[32:35], s74 offen offset:3072 nt
    s_waitcnt vmcnt(46)
    v_perm_b32 v50, v132, v128, s62
    v_perm_b32 v54, v132, v128, s63
    v_perm_b32 v58, v133, v129, s62
    v_perm_b32 v62, v133, v129, s63
    v_perm_b32 v66, v134, v130, s62
    v_perm_b32 v70, v134, v130, s63
    v_perm_b32 v74, v135, v131, s62
    v_perm_b32 v78, v135, v131, s63
    buffer_load_dwordx4 v[128:131], v3, s[32:35], s75 offen offset:0 nt
    buffer_load_dwordx4 v[132:135], v3, s[32:35], s75 offen offset:1024 nt
    s_waitcnt vmcnt(46)
    v_perm_b32 v51, v140, v136, s62
    v_perm_b32 v55, v140, v136, s63
    v_perm_b32 v59, v141, v137, s62
    v_perm_b32 v63, v141, v137, s63
    v_perm_b32 v67, v142, v138, s62
    v_perm_b32 v71, v142, v138, s63
    v_perm_b32 v75, v143, v139, s62
    v_perm_b32 v79, v143, v139, s63
    buffer_load_dwordx4 v[136:139], v3, s[32:35], s75 offen offset:2048 nt
    buffer_load_dwordx4 v[140:143], v3, s[32:35], s75 offen offset:3072 nt
    v_mfma_f32_16x16x32_bf16 v[16:19], v[48:51], v[192:195], v[16:19]
    v_mfma_f32_16x16x32_bf16 v[20:23], v[52:55], v[192:195], v[20:23]
    v_mfma_f32_16x16x32_bf16 v[24:27], v[56:59], v[192:195], v[24:27]
    v_mfma_f32_16x16x32_bf16 v[28:31], v[60:63], v[192:195], v[28:31]
    v_mfma_f32_16x16x32_bf16 v[32:35], v[64:67], v[192:195], v[32:35]
    v_mfma_f32_16x16x32_bf16 v[36:39], v[68:71], v[192:195], v[36:39]
    v_mfma_f32_16x16x32_bf16 v[40:43], v[72:75], v[192:195], v[40:43]
    v_mfma_f32_16x16x32_bf16 v[44:47], v[76:79], v[192:195], v[44:47]
    s_barrier
    s_add_u32 s74, s76, 10
    s_add_u32 s75, s76, 11
    s_and_b32 s74, s74, 15
    s_and_b32 s75, s75, 15
    s_lshl_b32 s74, s74, 12
    s_lshl_b32 s75, s75, 12
    s_waitcnt vmcnt(47)
    v_mfma_f32_16x16x32_bf16 v[48:51], a[64:67], v[4:7], 0
    buffer_load_dwordx4 a[64:67], v2, s[28:31], s74 offen offset:0 nt
    s_waitcnt vmcnt(47)
    v_mfma_f32_16x16x32_bf16 v[52:55], a[68:71], v[4:7], 0
    buffer_load_dwordx4 a[68:71], v2, s[28:31], s74 offen offset:1024 nt
    s_waitcnt vmcnt(47)
    v_mfma_f32_16x16x32_bf16 v[56:59], a[72:75], v[4:7], 0
    buffer_load_dwordx4 a[72:75], v2, s[28:31], s74 offen offset:2048 nt
    s_waitcnt vmcnt(47)
    v_mfma_f32_16x16x32_bf16 v[60:63], a[76:79], v[4:7], 0
    buffer_load_dwordx4 a[76:79], v2, s[28:31], s74 offen offset:3072 nt
    s_waitcnt vmcnt(47)
    v_mfma_f32_16x16x32_bf16 v[64:67], a[80:83], v[4:7], 0
    buffer_load_dwordx4 a[80:83], v2, s[28:31], s75 offen offset:0 nt
    s_waitcnt vmcnt(47)
    v_mfma_f32_16x16x32_bf16 v[68:71], a[84:87], v[4:7], 0
    buffer_load_dwordx4 a[84:87], v2, s[28:31], s75 offen offset:1024 nt
    s_waitcnt vmcnt(47)
    v_mfma_f32_16x16x32_bf16 v[72:75], a[88:91], v[4:7], 0
    buffer_load_dwordx4 a[88:91], v2, s[28:31], s75 offen offset:2048 nt
    s_waitcnt vmcnt(47)
    v_mfma_f32_16x16x32_bf16 v[76:79], a[92:95], v[4:7], 0
    buffer_load_dwordx4 a[92:95], v2, s[28:31], s75 offen offset:3072 nt
    v_mov_b32_dpp v176, v48 quad_perm:[0,0,0,0] row_mask:0xf bank_mask:0xf
    v_mov_b32_dpp v177, v52 quad_perm:[0,0,0,0] row_mask:0xf bank_mask:0xf
    v_mov_b32_dpp v178, v56 quad_perm:[0,0,0,0] row_mask:0xf bank_mask:0xf
    v_mov_b32_dpp v179, v60 quad_perm:[0,0,0,0] row_mask:0xf bank_mask:0xf
    v_mov_b32_dpp v180, v64 quad_perm:[0,0,0,0] row_mask:0xf bank_mask:0xf
    v_mov_b32_dpp v181, v68 quad_perm:[0,0,0,0] row_mask:0xf bank_mask:0xf
    v_mov_b32_dpp v182, v72 quad_perm:[0,0,0,0] row_mask:0xf bank_mask:0xf
    v_mov_b32_dpp v183, v76 quad_perm:[0,0,0,0] row_mask:0xf bank_mask:0xf
    v_add_f32_dpp v176, v49, v176 quad_perm:[1,1,1,1] row_mask:0xf bank_mask:0xf
    v_add_f32_dpp v177, v53, v177 quad_perm:[1,1,1,1] row_mask:0xf bank_mask:0xf
    v_add_f32_dpp v178, v57, v178 quad_perm:[1,1,1,1] row_mask:0xf bank_mask:0xf
    v_add_f32_dpp v179, v61, v179 quad_perm:[1,1,1,1] row_mask:0xf bank_mask:0xf
    v_add_f32_dpp v180, v65, v180 quad_perm:[1,1,1,1] row_mask:0xf bank_mask:0xf
    v_add_f32_dpp v181, v69, v181 quad_perm:[1,1,1,1] row_mask:0xf bank_mask:0xf
    v_add_f32_dpp v182, v73, v182 quad_perm:[1,1,1,1] row_mask:0xf bank_mask:0xf
    v_add_f32_dpp v183, v77, v183 quad_perm:[1,1,1,1] row_mask:0xf bank_mask:0xf
    v_add_f32_dpp v176, v50, v176 quad_perm:[2,2,2,2] row_mask:0xf bank_mask:0xf
    v_add_f32_dpp v177, v54, v177 quad_perm:[2,2,2,2] row_mask:0xf bank_mask:0xf
    v_add_f32_dpp v178, v58, v178 quad_perm:[2,2,2,2] row_mask:0xf bank_mask:0xf
    v_add_f32_dpp v179, v62, v179 quad_perm:[2,2,2,2] row_mask:0xf bank_mask:0xf
    v_add_f32_dpp v180, v66, v180 quad_perm:[2,2,2,2] row_mask:0xf bank_mask:0xf
    v_add_f32_dpp v181, v70, v181 quad_perm:[2,2,2,2] row_mask:0xf bank_mask:0xf
    v_add_f32_dpp v182, v74, v182 quad_perm:[2,2,2,2] row_mask:0xf bank_mask:0xf
    v_add_f32_dpp v183, v78, v183 quad_perm:[2,2,2,2] row_mask:0xf bank_mask:0xf
    v_add_f32_dpp v176, v51, v176 quad_perm:[3,3,3,3] row_mask:0xf bank_mask:0xf
    v_add_f32_dpp v177, v55, v177 quad_perm:[3,3,3,3] row_mask:0xf bank_mask:0xf
    v_add_f32_dpp v178, v59, v178 quad_perm:[3,3,3,3] row_mask:0xf bank_mask:0xf
    v_add_f32_dpp v179, v63, v179 quad_perm:[3,3,3,3] row_mask:0xf bank_mask:0xf
    v_add_f32_dpp v180, v67, v180 quad_perm:[3,3,3,3] row_mask:0xf bank_mask:0xf
    v_add_f32_dpp v181, v71, v181 quad_perm:[3,3,3,3] row_mask:0xf bank_mask:0xf
    v_add_f32_dpp v182, v75, v182 quad_perm:[3,3,3,3] row_mask:0xf bank_mask:0xf
    v_add_f32_dpp v183, v79, v183 quad_perm:[3,3,3,3] row_mask:0xf bank_mask:0xf
    v_cvt_pk_bf16_f32 v192, v176, v177
    v_cvt_pk_bf16_f32 v193, v178, v179
    v_cvt_pk_bf16_f32 v194, v180, v181
    v_cvt_pk_bf16_f32 v195, v182, v183
    v_lshlrev_b32 v184, 16, v192
    v_and_b32 v185, 0xffff0000, v192
    v_lshlrev_b32 v186, 16, v193
    v_and_b32 v187, 0xffff0000, v193
    v_lshlrev_b32 v188, 16, v194
    v_and_b32 v189, 0xffff0000, v194
    v_lshlrev_b32 v190, 16, v195
    v_and_b32 v191, 0xffff0000, v195
    v_pk_mul_f32 v[184:185], v[184:185], s[70:71]
    v_pk_mul_f32 v[186:187], v[186:187], s[70:71]
    v_pk_mul_f32 v[188:189], v[188:189], s[70:71]
    v_pk_mul_f32 v[190:191], v[190:191], s[70:71]
    v_cvt_pk_bf16_f32 v192, v184, v185
    v_cvt_pk_bf16_f32 v193, v186, v187
    v_cvt_pk_bf16_f32 v194, v188, v189
    v_cvt_pk_bf16_f32 v195, v190, v191
    v_lshlrev_b32 v176, 16, v192
    v_and_b32 v177, 0xffff0000, v192
    v_lshlrev_b32 v178, 16, v193
    v_and_b32 v179, 0xffff0000, v193
    v_lshlrev_b32 v180, 16, v194
    v_and_b32 v181, 0xffff0000, v194
    v_lshlrev_b32 v182, 16, v195
    v_and_b32 v183, 0xffff0000, v195
    v_max3_f32 v12, v176, v177, v178
    v_max3_f32 v13, v179, v180, v181
    v_max3_f32 v12, v12, v182, v183
    v_max_f32 v12, v12, v13
    v_mov_b32 v13, v12
    s_nop 1
    v_permlane16_swap_b32 v12, v13
    v_max_f32 v12, v12, v13
    v_mov_b32 v13, v12
    s_nop 1
    v_permlane32_swap_b32 v12, v13
    v_max_f32 v12, v12, v13
    v_max_f32 v12, v12, v8
    v_sub_f32 v10, v8, v12
    v_mul_f32 v10, s72, v10
    v_mov_b32 v8, v12
    v_mul_f32 v13, s72, v12
    v_exp_f32 v10, v10
    v_fma_f32 v184, v176, s72, -v13
    v_fma_f32 v185, v177, s72, -v13
    v_fma_f32 v186, v178, s72, -v13
    v_fma_f32 v187, v179, s72, -v13
    v_fma_f32 v188, v180, s72, -v13
    v_fma_f32 v189, v181, s72, -v13
    v_fma_f32 v190, v182, s72, -v13
    v_fma_f32 v191, v183, s72, -v13
    v_exp_f32 v184, v184
    v_exp_f32 v185, v185
    v_exp_f32 v186, v186
    v_exp_f32 v187, v187
    v_exp_f32 v188, v188
    v_exp_f32 v189, v189
    v_exp_f32 v190, v190
    v_exp_f32 v191, v191
    v_cvt_pk_bf16_f32 v192, v184, v185
    v_cvt_pk_bf16_f32 v193, v186, v187
    v_cvt_pk_bf16_f32 v194, v188, v189
    v_cvt_pk_bf16_f32 v195, v190, v191
    v_pk_add_f32 v[184:185], v[184:185], v[186:187]
    v_pk_add_f32 v[188:189], v[188:189], v[190:191]
    v_pk_add_f32 v[184:185], v[184:185], v[188:189]
    v_fma_f32 v9, v9, v10, v184
    v_add_f32 v9, v9, v185
    v_pk_mul_f32 v[16:17], v[16:17], v[10:11] op_sel_hi:[1,0]
    v_pk_mul_f32 v[18:19], v[18:19], v[10:11] op_sel_hi:[1,0]
    v_pk_mul_f32 v[20:21], v[20:21], v[10:11] op_sel_hi:[1,0]
    v_pk_mul_f32 v[22:23], v[22:23], v[10:11] op_sel_hi:[1,0]
    v_pk_mul_f32 v[24:25], v[24:25], v[10:11] op_sel_hi:[1,0]
    v_pk_mul_f32 v[26:27], v[26:27], v[10:11] op_sel_hi:[1,0]
    v_pk_mul_f32 v[28:29], v[28:29], v[10:11] op_sel_hi:[1,0]
    v_pk_mul_f32 v[30:31], v[30:31], v[10:11] op_sel_hi:[1,0]
    v_pk_mul_f32 v[32:33], v[32:33], v[10:11] op_sel_hi:[1,0]
    v_pk_mul_f32 v[34:35], v[34:35], v[10:11] op_sel_hi:[1,0]
    v_pk_mul_f32 v[36:37], v[36:37], v[10:11] op_sel_hi:[1,0]
    v_pk_mul_f32 v[38:39], v[38:39], v[10:11] op_sel_hi:[1,0]
    v_pk_mul_f32 v[40:41], v[40:41], v[10:11] op_sel_hi:[1,0]
    v_pk_mul_f32 v[42:43], v[42:43], v[10:11] op_sel_hi:[1,0]
    v_pk_mul_f32 v[44:45], v[44:45], v[10:11] op_sel_hi:[1,0]
    v_pk_mul_f32 v[46:47], v[46:47], v[10:11] op_sel_hi:[1,0]
    s_waitcnt vmcnt(46)
    v_perm_b32 v48, v148, v144, s62
    v_perm_b32 v52, v148, v144, s63
    v_perm_b32 v56, v149, v145, s62
    v_perm_b32 v60, v149, v145, s63
    v_perm_b32 v64, v150, v146, s62
    v_perm_b32 v68, v150, v146, s63
    v_perm_b32 v72, v151, v147, s62
    v_perm_b32 v76, v151, v147, s63
    buffer_load_dwordx4 v[144:147], v3, s[32:35], s74 offen offset:0 nt
    buffer_load_dwordx4 v[148:151], v3, s[32:35], s74 offen offset:1024 nt
    s_waitcnt vmcnt(46)
    v_perm_b32 v49, v156, v152, s62
    v_perm_b32 v53, v156, v152, s63
    v_perm_b32 v57, v157, v153, s62
    v_perm_b32 v61, v157, v153, s63
    v_perm_b32 v65, v158, v154, s62
    v_perm_b32 v69, v158, v154, s63
    v_perm_b32 v73, v159, v155, s62
    v_perm_b32 v77, v159, v155, s63
    buffer_load_dwordx4 v[152:155], v3, s[32:35], s74 offen offset:2048 nt
    buffer_load_dwordx4 v[156:159], v3, s[32:35], s74 offen offset:3072 nt
    s_waitcnt vmcnt(46)
    v_perm_b32 v50, v164, v160, s62
    v_perm_b32 v54, v164, v160, s63
    v_perm_b32 v58, v165, v161, s62
    v_perm_b32 v62, v165, v161, s63
    v_perm_b32 v66, v166, v162, s62
    v_perm_b32 v70, v166, v162, s63
    v_perm_b32 v74, v167, v163, s62
    v_perm_b32 v78, v167, v163, s63
    buffer_load_dwordx4 v[160:163], v3, s[32:35], s75 offen offset:0 nt
    buffer_load_dwordx4 v[164:167], v3, s[32:35], s75 offen offset:1024 nt
    s_waitcnt vmcnt(46)
    v_perm_b32 v51, v172, v168, s62
    v_perm_b32 v55, v172, v168, s63
    v_perm_b32 v59, v173, v169, s62
    v_perm_b32 v63, v173, v169, s63
    v_perm_b32 v67, v174, v170, s62
    v_perm_b32 v71, v174, v170, s63
    v_perm_b32 v75, v175, v171, s62
    v_perm_b32 v79, v175, v171, s63
    buffer_load_dwordx4 v[168:171], v3, s[32:35], s75 offen offset:2048 nt
    buffer_load_dwordx4 v[172:175], v3, s[32:35], s75 offen offset:3072 nt
    v_mfma_f32_16x16x32_bf16 v[16:19], v[48:51], v[192:195], v[16:19]
    v_mfma_f32_16x16x32_bf16 v[20:23], v[52:55], v[192:195], v[20:23]
    v_mfma_f32_16x16x32_bf16 v[24:27], v[56:59], v[192:195], v[24:27]
    v_mfma_f32_16x16x32_bf16 v[28:31], v[60:63], v[192:195], v[28:31]
    v_mfma_f32_16x16x32_bf16 v[32:35], v[64:67], v[192:195], v[32:35]
    v_mfma_f32_16x16x32_bf16 v[36:39], v[68:71], v[192:195], v[36:39]
    v_mfma_f32_16x16x32_bf16 v[40:43], v[72:75], v[192:195], v[40:43]
    v_mfma_f32_16x16x32_bf16 v[44:47], v[76:79], v[192:195], v[44:47]
    s_waitcnt vmcnt(47)
    v_mfma_f32_16x16x32_bf16 v[48:51], a[0:3], v[4:7], 0
    s_waitcnt vmcnt(46)
    v_mfma_f32_16x16x32_bf16 v[52:55], a[4:7], v[4:7], 0
    s_waitcnt vmcnt(45)
    v_mfma_f32_16x16x32_bf16 v[56:59], a[8:11], v[4:7], 0
    s_waitcnt vmcnt(44)
    v_mfma_f32_16x16x32_bf16 v[60:63], a[12:15], v[4:7], 0
    s_waitcnt vmcnt(43)
    v_mfma_f32_16x16x32_bf16 v[64:67], a[16:19], v[4:7], 0
    s_waitcnt vmcnt(42)
    v_mfma_f32_16x16x32_bf16 v[68:71], a[20:23], v[4:7], 0
    s_waitcnt vmcnt(41)
    v_mfma_f32_16x16x32_bf16 v[72:75], a[24:27], v[4:7], 0
    s_waitcnt vmcnt(40)
    v_mfma_f32_16x16x32_bf16 v[76:79], a[28:31], v[4:7], 0
    v_mov_b32_dpp v176, v48 quad_perm:[0,0,0,0] row_mask:0xf bank_mask:0xf
    v_mov_b32_dpp v177, v52 quad_perm:[0,0,0,0] row_mask:0xf bank_mask:0xf
    v_mov_b32_dpp v178, v56 quad_perm:[0,0,0,0] row_mask:0xf bank_mask:0xf
    v_mov_b32_dpp v179, v60 quad_perm:[0,0,0,0] row_mask:0xf bank_mask:0xf
    v_mov_b32_dpp v180, v64 quad_perm:[0,0,0,0] row_mask:0xf bank_mask:0xf
    v_mov_b32_dpp v181, v68 quad_perm:[0,0,0,0] row_mask:0xf bank_mask:0xf
    v_mov_b32_dpp v182, v72 quad_perm:[0,0,0,0] row_mask:0xf bank_mask:0xf
    s_nop 0
    v_mov_b32_dpp v183, v76 quad_perm:[0,0,0,0] row_mask:0xf bank_mask:0xf
    v_add_f32_dpp v176, v49, v176 quad_perm:[1,1,1,1] row_mask:0xf bank_mask:0xf
    v_add_f32_dpp v177, v53, v177 quad_perm:[1,1,1,1] row_mask:0xf bank_mask:0xf
    v_add_f32_dpp v178, v57, v178 quad_perm:[1,1,1,1] row_mask:0xf bank_mask:0xf
    v_add_f32_dpp v179, v61, v179 quad_perm:[1,1,1,1] row_mask:0xf bank_mask:0xf
    v_add_f32_dpp v180, v65, v180 quad_perm:[1,1,1,1] row_mask:0xf bank_mask:0xf
    v_add_f32_dpp v181, v69, v181 quad_perm:[1,1,1,1] row_mask:0xf bank_mask:0xf
    v_add_f32_dpp v182, v73, v182 quad_perm:[1,1,1,1] row_mask:0xf bank_mask:0xf
    v_add_f32_dpp v183, v77, v183 quad_perm:[1,1,1,1] row_mask:0xf bank_mask:0xf
    v_add_f32_dpp v176, v50, v176 quad_perm:[2,2,2,2] row_mask:0xf bank_mask:0xf
    v_add_f32_dpp v177, v54, v177 quad_perm:[2,2,2,2] row_mask:0xf bank_mask:0xf
    v_add_f32_dpp v178, v58, v178 quad_perm:[2,2,2,2] row_mask:0xf bank_mask:0xf
    v_add_f32_dpp v179, v62, v179 quad_perm:[2,2,2,2] row_mask:0xf bank_mask:0xf
    v_add_f32_dpp v180, v66, v180 quad_perm:[2,2,2,2] row_mask:0xf bank_mask:0xf
    v_add_f32_dpp v181, v70, v181 quad_perm:[2,2,2,2] row_mask:0xf bank_mask:0xf
    v_add_f32_dpp v182, v74, v182 quad_perm:[2,2,2,2] row_mask:0xf bank_mask:0xf
    v_add_f32_dpp v183, v78, v183 quad_perm:[2,2,2,2] row_mask:0xf bank_mask:0xf
    v_add_f32_dpp v176, v51, v176 quad_perm:[3,3,3,3] row_mask:0xf bank_mask:0xf
    v_add_f32_dpp v177, v55, v177 quad_perm:[3,3,3,3] row_mask:0xf bank_mask:0xf
    v_add_f32_dpp v178, v59, v178 quad_perm:[3,3,3,3] row_mask:0xf bank_mask:0xf
    v_add_f32_dpp v179, v63, v179 quad_perm:[3,3,3,3] row_mask:0xf bank_mask:0xf
    v_add_f32_dpp v180, v67, v180 quad_perm:[3,3,3,3] row_mask:0xf bank_mask:0xf
    v_add_f32_dpp v181, v71, v181 quad_perm:[3,3,3,3] row_mask:0xf bank_mask:0xf
    v_add_f32_dpp v182, v75, v182 quad_perm:[3,3,3,3] row_mask:0xf bank_mask:0xf
    v_add_f32_dpp v183, v79, v183 quad_perm:[3,3,3,3] row_mask:0xf bank_mask:0xf
    v_cvt_pk_bf16_f32 v192, v176, v177
    v_cvt_pk_bf16_f32 v193, v178, v179
    v_cvt_pk_bf16_f32 v194, v180, v181
    v_cvt_pk_bf16_f32 v195, v182, v183
    v_lshlrev_b32 v184, 16, v192
    v_and_b32 v185, 0xffff0000, v192
    v_lshlrev_b32 v186, 16, v193
    v_and_b32 v187, 0xffff0000, v193
    v_lshlrev_b32 v188, 16, v194
    v_and_b32 v189, 0xffff0000, v194
    v_lshlrev_b32 v190, 16, v195
    v_and_b32 v191, 0xffff0000, v195
    v_pk_mul_f32 v[184:185], v[184:185], s[70:71]
    v_pk_mul_f32 v[186:187], v[186:187], s[70:71]
    v_pk_mul_f32 v[188:189], v[188:189], s[70:71]
    v_pk_mul_f32 v[190:191], v[190:191], s[70:71]
    v_cvt_pk_bf16_f32 v192, v184, v185
    v_cvt_pk_bf16_f32 v193, v186, v187
    v_cvt_pk_bf16_f32 v194, v188, v189
    v_cvt_pk_bf16_f32 v195, v190, v191
    v_lshlrev_b32 v176, 16, v192
    v_and_b32 v177, 0xffff0000, v192
    v_lshlrev_b32 v178, 16, v193
    v_and_b32 v179, 0xffff0000, v193
    v_lshlrev_b32 v180, 16, v194
    v_and_b32 v181, 0xffff0000, v194
    v_lshlrev_b32 v182, 16, v195
    v_and_b32 v183, 0xffff0000, v195
    v_max3_f32 v12, v176, v177, v178
    v_max3_f32 v13, v179, v180, v181
    v_max3_f32 v12, v12, v182, v183
    v_max_f32 v12, v12, v13
    v_mov_b32 v13, v12
    s_nop 1
    v_permlane16_swap_b32 v12, v13
    v_max_f32 v12, v12, v13
    v_mov_b32 v13, v12
    s_nop 1
    v_permlane32_swap_b32 v12, v13
    v_max_f32 v12, v12, v13
    v_max_f32 v12, v12, v8
    v_sub_f32 v10, v8, v12
    v_mul_f32 v10, s72, v10
    v_mov_b32 v8, v12
    v_mul_f32 v13, s72, v12
    v_exp_f32 v10, v10
    v_fma_f32 v184, v176, s72, -v13
    v_fma_f32 v185, v177, s72, -v13
    v_fma_f32 v186, v178, s72, -v13
    v_fma_f32 v187, v179, s72, -v13
    v_fma_f32 v188, v180, s72, -v13
    v_fma_f32 v189, v181, s72, -v13
    v_fma_f32 v190, v182, s72, -v13
    v_fma_f32 v191, v183, s72, -v13
    v_exp_f32 v184, v184
    v_exp_f32 v185, v185
    v_exp_f32 v186, v186
    v_exp_f32 v187, v187
    v_exp_f32 v188, v188
    v_exp_f32 v189, v189
    v_exp_f32 v190, v190
    v_exp_f32 v191, v191
    v_cvt_pk_bf16_f32 v192, v184, v185
    v_cvt_pk_bf16_f32 v193, v186, v187
    v_cvt_pk_bf16_f32 v194, v188, v189
    v_cvt_pk_bf16_f32 v195, v190, v191
    v_pk_add_f32 v[184:185], v[184:185], v[186:187]
    v_pk_add_f32 v[188:189], v[188:189], v[190:191]
    v_pk_add_f32 v[184:185], v[184:185], v[188:189]
    v_fma_f32 v9, v9, v10, v184
    v_add_f32 v9, v9, v185
    v_pk_mul_f32 v[16:17], v[16:17], v[10:11] op_sel_hi:[1,0]
    v_pk_mul_f32 v[18:19], v[18:19], v[10:11] op_sel_hi:[1,0]
    v_pk_mul_f32 v[20:21], v[20:21], v[10:11] op_sel_hi:[1,0]
    v_pk_mul_f32 v[22:23], v[22:23], v[10:11] op_sel_hi:[1,0]
    v_pk_mul_f32 v[24:25], v[24:25], v[10:11] op_sel_hi:[1,0]
    v_pk_mul_f32 v[26:27], v[26:27], v[10:11] op_sel_hi:[1,0]
    v_pk_mul_f32 v[28:29], v[28:29], v[10:11] op_sel_hi:[1,0]
    v_pk_mul_f32 v[30:31], v[30:31], v[10:11] op_sel_hi:[1,0]
    v_pk_mul_f32 v[32:33], v[32:33], v[10:11] op_sel_hi:[1,0]
    v_pk_mul_f32 v[34:35], v[34:35], v[10:11] op_sel_hi:[1,0]
    v_pk_mul_f32 v[36:37], v[36:37], v[10:11] op_sel_hi:[1,0]
    v_pk_mul_f32 v[38:39], v[38:39], v[10:11] op_sel_hi:[1,0]
    v_pk_mul_f32 v[40:41], v[40:41], v[10:11] op_sel_hi:[1,0]
    v_pk_mul_f32 v[42:43], v[42:43], v[10:11] op_sel_hi:[1,0]
    v_pk_mul_f32 v[44:45], v[44:45], v[10:11] op_sel_hi:[1,0]
    v_pk_mul_f32 v[46:47], v[46:47], v[10:11] op_sel_hi:[1,0]
    s_waitcnt vmcnt(38)
    v_perm_b32 v48, v84, v80, s62
    v_perm_b32 v52, v84, v80, s63
    v_perm_b32 v56, v85, v81, s62
    v_perm_b32 v60, v85, v81, s63
    v_perm_b32 v64, v86, v82, s62
    v_perm_b32 v68, v86, v82, s63
    v_perm_b32 v72, v87, v83, s62
    v_perm_b32 v76, v87, v83, s63
    s_waitcnt vmcnt(36)
    v_perm_b32 v49, v92, v88, s62
    v_perm_b32 v53, v92, v88, s63
    v_perm_b32 v57, v93, v89, s62
    v_perm_b32 v61, v93, v89, s63
    v_perm_b32 v65, v94, v90, s62
    v_perm_b32 v69, v94, v90, s63
    v_perm_b32 v73, v95, v91, s62
    v_perm_b32 v77, v95, v91, s63
    s_waitcnt vmcnt(34)
    v_perm_b32 v50, v100, v96, s62
    v_perm_b32 v54, v100, v96, s63
    v_perm_b32 v58, v101, v97, s62
    v_perm_b32 v62, v101, v97, s63
    v_perm_b32 v66, v102, v98, s62
    v_perm_b32 v70, v102, v98, s63
    v_perm_b32 v74, v103, v99, s62
    v_perm_b32 v78, v103, v99, s63
    s_waitcnt vmcnt(32)
    v_perm_b32 v51, v108, v104, s62
    v_perm_b32 v55, v108, v104, s63
    v_perm_b32 v59, v109, v105, s62
    v_perm_b32 v63, v109, v105, s63
    v_perm_b32 v67, v110, v106, s62
    v_perm_b32 v71, v110, v106, s63
    v_perm_b32 v75, v111, v107, s62
    v_perm_b32 v79, v111, v107, s63
    v_mfma_f32_16x16x32_bf16 v[16:19], v[48:51], v[192:195], v[16:19]
    v_mfma_f32_16x16x32_bf16 v[20:23], v[52:55], v[192:195], v[20:23]
    v_mfma_f32_16x16x32_bf16 v[24:27], v[56:59], v[192:195], v[24:27]
    v_mfma_f32_16x16x32_bf16 v[28:31], v[60:63], v[192:195], v[28:31]
    v_mfma_f32_16x16x32_bf16 v[32:35], v[64:67], v[192:195], v[32:35]
    v_mfma_f32_16x16x32_bf16 v[36:39], v[68:71], v[192:195], v[36:39]
    v_mfma_f32_16x16x32_bf16 v[40:43], v[72:75], v[192:195], v[40:43]
    v_mfma_f32_16x16x32_bf16 v[44:47], v[76:79], v[192:195], v[44:47]
    s_barrier
    s_add_u32 s74, s76, 12
    s_add_u32 s75, s76, 13
    s_and_b32 s74, s74, 15
    s_and_b32 s75, s75, 15
    s_lshl_b32 s74, s74, 12
    s_lshl_b32 s75, s75, 12
    s_waitcnt vmcnt(31)
    v_mfma_f32_16x16x32_bf16 v[48:51], a[32:35], v[4:7], 0
    buffer_load_dwordx4 a[0:3], v2, s[28:31], s74 offen offset:0 nt
    s_waitcnt vmcnt(31)
    v_mfma_f32_16x16x32_bf16 v[52:55], a[36:39], v[4:7], 0
    buffer_load_dwordx4 a[4:7], v2, s[28:31], s74 offen offset:1024 nt
    s_waitcnt vmcnt(31)
    v_mfma_f32_16x16x32_bf16 v[56:59], a[40:43], v[4:7], 0
    buffer_load_dwordx4 a[8:11], v2, s[28:31], s74 offen offset:2048 nt
    s_waitcnt vmcnt(31)
    v_mfma_f32_16x16x32_bf16 v[60:63], a[44:47], v[4:7], 0
    buffer_load_dwordx4 a[12:15], v2, s[28:31], s74 offen offset:3072 nt
    s_waitcnt vmcnt(31)
    v_mfma_f32_16x16x32_bf16 v[64:67], a[48:51], v[4:7], 0
    buffer_load_dwordx4 a[16:19], v2, s[28:31], s75 offen offset:0 nt
    s_waitcnt vmcnt(31)
    v_mfma_f32_16x16x32_bf16 v[68:71], a[52:55], v[4:7], 0
    buffer_load_dwordx4 a[20:23], v2, s[28:31], s75 offen offset:1024 nt
    s_waitcnt vmcnt(31)
    v_mfma_f32_16x16x32_bf16 v[72:75], a[56:59], v[4:7], 0
    buffer_load_dwordx4 a[24:27], v2, s[28:31], s75 offen offset:2048 nt
    s_waitcnt vmcnt(31)
    v_mfma_f32_16x16x32_bf16 v[76:79], a[60:63], v[4:7], 0
    buffer_load_dwordx4 a[28:31], v2, s[28:31], s75 offen offset:3072 nt
    v_mov_b32_dpp v176, v48 quad_perm:[0,0,0,0] row_mask:0xf bank_mask:0xf
    v_mov_b32_dpp v177, v52 quad_perm:[0,0,0,0] row_mask:0xf bank_mask:0xf
    v_mov_b32_dpp v178, v56 quad_perm:[0,0,0,0] row_mask:0xf bank_mask:0xf
    v_mov_b32_dpp v179, v60 quad_perm:[0,0,0,0] row_mask:0xf bank_mask:0xf
    v_mov_b32_dpp v180, v64 quad_perm:[0,0,0,0] row_mask:0xf bank_mask:0xf
    v_mov_b32_dpp v181, v68 quad_perm:[0,0,0,0] row_mask:0xf bank_mask:0xf
    v_mov_b32_dpp v182, v72 quad_perm:[0,0,0,0] row_mask:0xf bank_mask:0xf
    v_mov_b32_dpp v183, v76 quad_perm:[0,0,0,0] row_mask:0xf bank_mask:0xf
    v_add_f32_dpp v176, v49, v176 quad_perm:[1,1,1,1] row_mask:0xf bank_mask:0xf
    v_add_f32_dpp v177, v53, v177 quad_perm:[1,1,1,1] row_mask:0xf bank_mask:0xf
    v_add_f32_dpp v178, v57, v178 quad_perm:[1,1,1,1] row_mask:0xf bank_mask:0xf
    v_add_f32_dpp v179, v61, v179 quad_perm:[1,1,1,1] row_mask:0xf bank_mask:0xf
    v_add_f32_dpp v180, v65, v180 quad_perm:[1,1,1,1] row_mask:0xf bank_mask:0xf
    v_add_f32_dpp v181, v69, v181 quad_perm:[1,1,1,1] row_mask:0xf bank_mask:0xf
    v_add_f32_dpp v182, v73, v182 quad_perm:[1,1,1,1] row_mask:0xf bank_mask:0xf
    v_add_f32_dpp v183, v77, v183 quad_perm:[1,1,1,1] row_mask:0xf bank_mask:0xf
    v_add_f32_dpp v176, v50, v176 quad_perm:[2,2,2,2] row_mask:0xf bank_mask:0xf
    v_add_f32_dpp v177, v54, v177 quad_perm:[2,2,2,2] row_mask:0xf bank_mask:0xf
    v_add_f32_dpp v178, v58, v178 quad_perm:[2,2,2,2] row_mask:0xf bank_mask:0xf
    v_add_f32_dpp v179, v62, v179 quad_perm:[2,2,2,2] row_mask:0xf bank_mask:0xf
    v_add_f32_dpp v180, v66, v180 quad_perm:[2,2,2,2] row_mask:0xf bank_mask:0xf
    v_add_f32_dpp v181, v70, v181 quad_perm:[2,2,2,2] row_mask:0xf bank_mask:0xf
    v_add_f32_dpp v182, v74, v182 quad_perm:[2,2,2,2] row_mask:0xf bank_mask:0xf
    v_add_f32_dpp v183, v78, v183 quad_perm:[2,2,2,2] row_mask:0xf bank_mask:0xf
    v_add_f32_dpp v176, v51, v176 quad_perm:[3,3,3,3] row_mask:0xf bank_mask:0xf
    v_add_f32_dpp v177, v55, v177 quad_perm:[3,3,3,3] row_mask:0xf bank_mask:0xf
    v_add_f32_dpp v178, v59, v178 quad_perm:[3,3,3,3] row_mask:0xf bank_mask:0xf
    v_add_f32_dpp v179, v63, v179 quad_perm:[3,3,3,3] row_mask:0xf bank_mask:0xf
    v_add_f32_dpp v180, v67, v180 quad_perm:[3,3,3,3] row_mask:0xf bank_mask:0xf
    v_add_f32_dpp v181, v71, v181 quad_perm:[3,3,3,3] row_mask:0xf bank_mask:0xf
    v_add_f32_dpp v182, v75, v182 quad_perm:[3,3,3,3] row_mask:0xf bank_mask:0xf
    v_add_f32_dpp v183, v79, v183 quad_perm:[3,3,3,3] row_mask:0xf bank_mask:0xf
    v_cvt_pk_bf16_f32 v192, v176, v177
    v_cvt_pk_bf16_f32 v193, v178, v179
    v_cvt_pk_bf16_f32 v194, v180, v181
    v_cvt_pk_bf16_f32 v195, v182, v183
    v_lshlrev_b32 v184, 16, v192
    v_and_b32 v185, 0xffff0000, v192
    v_lshlrev_b32 v186, 16, v193
    v_and_b32 v187, 0xffff0000, v193
    v_lshlrev_b32 v188, 16, v194
    v_and_b32 v189, 0xffff0000, v194
    v_lshlrev_b32 v190, 16, v195
    v_and_b32 v191, 0xffff0000, v195
    v_pk_mul_f32 v[184:185], v[184:185], s[70:71]
    v_pk_mul_f32 v[186:187], v[186:187], s[70:71]
    v_pk_mul_f32 v[188:189], v[188:189], s[70:71]
    v_pk_mul_f32 v[190:191], v[190:191], s[70:71]
    v_cvt_pk_bf16_f32 v192, v184, v185
    v_cvt_pk_bf16_f32 v193, v186, v187
    v_cvt_pk_bf16_f32 v194, v188, v189
    v_cvt_pk_bf16_f32 v195, v190, v191
    v_lshlrev_b32 v176, 16, v192
    v_and_b32 v177, 0xffff0000, v192
    v_lshlrev_b32 v178, 16, v193
    v_and_b32 v179, 0xffff0000, v193
    v_lshlrev_b32 v180, 16, v194
    v_and_b32 v181, 0xffff0000, v194
    v_lshlrev_b32 v182, 16, v195
    v_and_b32 v183, 0xffff0000, v195
    v_max3_f32 v12, v176, v177, v178
    v_max3_f32 v13, v179, v180, v181
    v_max3_f32 v12, v12, v182, v183
    v_max_f32 v12, v12, v13
    v_mov_b32 v13, v12
    s_nop 1
    v_permlane16_swap_b32 v12, v13
    v_max_f32 v12, v12, v13
    v_mov_b32 v13, v12
    s_nop 1
    v_permlane32_swap_b32 v12, v13
    v_max_f32 v12, v12, v13
    v_max_f32 v12, v12, v8
    v_sub_f32 v10, v8, v12
    v_mul_f32 v10, s72, v10
    v_mov_b32 v8, v12
    v_mul_f32 v13, s72, v12
    v_exp_f32 v10, v10
    v_fma_f32 v184, v176, s72, -v13
    v_fma_f32 v185, v177, s72, -v13
    v_fma_f32 v186, v178, s72, -v13
    v_fma_f32 v187, v179, s72, -v13
    v_fma_f32 v188, v180, s72, -v13
    v_fma_f32 v189, v181, s72, -v13
    v_fma_f32 v190, v182, s72, -v13
    v_fma_f32 v191, v183, s72, -v13
    v_exp_f32 v184, v184
    v_exp_f32 v185, v185
    v_exp_f32 v186, v186
    v_exp_f32 v187, v187
    v_exp_f32 v188, v188
    v_exp_f32 v189, v189
    v_exp_f32 v190, v190
    v_exp_f32 v191, v191
    v_cvt_pk_bf16_f32 v192, v184, v185
    v_cvt_pk_bf16_f32 v193, v186, v187
    v_cvt_pk_bf16_f32 v194, v188, v189
    v_cvt_pk_bf16_f32 v195, v190, v191
    v_pk_add_f32 v[184:185], v[184:185], v[186:187]
    v_pk_add_f32 v[188:189], v[188:189], v[190:191]
    v_pk_add_f32 v[184:185], v[184:185], v[188:189]
    v_fma_f32 v9, v9, v10, v184
    v_add_f32 v9, v9, v185
    v_pk_mul_f32 v[16:17], v[16:17], v[10:11] op_sel_hi:[1,0]
    v_pk_mul_f32 v[18:19], v[18:19], v[10:11] op_sel_hi:[1,0]
    v_pk_mul_f32 v[20:21], v[20:21], v[10:11] op_sel_hi:[1,0]
    v_pk_mul_f32 v[22:23], v[22:23], v[10:11] op_sel_hi:[1,0]
    v_pk_mul_f32 v[24:25], v[24:25], v[10:11] op_sel_hi:[1,0]
    v_pk_mul_f32 v[26:27], v[26:27], v[10:11] op_sel_hi:[1,0]
    v_pk_mul_f32 v[28:29], v[28:29], v[10:11] op_sel_hi:[1,0]
    v_pk_mul_f32 v[30:31], v[30:31], v[10:11] op_sel_hi:[1,0]
    v_pk_mul_f32 v[32:33], v[32:33], v[10:11] op_sel_hi:[1,0]
    v_pk_mul_f32 v[34:35], v[34:35], v[10:11] op_sel_hi:[1,0]
    v_pk_mul_f32 v[36:37], v[36:37], v[10:11] op_sel_hi:[1,0]
    v_pk_mul_f32 v[38:39], v[38:39], v[10:11] op_sel_hi:[1,0]
    v_pk_mul_f32 v[40:41], v[40:41], v[10:11] op_sel_hi:[1,0]
    v_pk_mul_f32 v[42:43], v[42:43], v[10:11] op_sel_hi:[1,0]
    v_pk_mul_f32 v[44:45], v[44:45], v[10:11] op_sel_hi:[1,0]
    v_pk_mul_f32 v[46:47], v[46:47], v[10:11] op_sel_hi:[1,0]
    s_waitcnt vmcnt(30)
    v_perm_b32 v48, v116, v112, s62
    v_perm_b32 v52, v116, v112, s63
    v_perm_b32 v56, v117, v113, s62
    v_perm_b32 v60, v117, v113, s63
    v_perm_b32 v64, v118, v114, s62
    v_perm_b32 v68, v118, v114, s63
    v_perm_b32 v72, v119, v115, s62
    v_perm_b32 v76, v119, v115, s63
    buffer_load_dwordx4 v[80:83], v3, s[32:35], s74 offen offset:0 nt
    buffer_load_dwordx4 v[84:87], v3, s[32:35], s74 offen offset:1024 nt
    s_waitcnt vmcnt(30)
    v_perm_b32 v49, v124, v120, s62
    v_perm_b32 v53, v124, v120, s63
    v_perm_b32 v57, v125, v121, s62
    v_perm_b32 v61, v125, v121, s63
    v_perm_b32 v65, v126, v122, s62
    v_perm_b32 v69, v126, v122, s63
    v_perm_b32 v73, v127, v123, s62
    v_perm_b32 v77, v127, v123, s63
    buffer_load_dwordx4 v[88:91], v3, s[32:35], s74 offen offset:2048 nt
    buffer_load_dwordx4 v[92:95], v3, s[32:35], s74 offen offset:3072 nt
    s_waitcnt vmcnt(30)
    v_perm_b32 v50, v132, v128, s62
    v_perm_b32 v54, v132, v128, s63
    v_perm_b32 v58, v133, v129, s62
    v_perm_b32 v62, v133, v129, s63
    v_perm_b32 v66, v134, v130, s62
    v_perm_b32 v70, v134, v130, s63
    v_perm_b32 v74, v135, v131, s62
    v_perm_b32 v78, v135, v131, s63
    buffer_load_dwordx4 v[96:99], v3, s[32:35], s75 offen offset:0 nt
    buffer_load_dwordx4 v[100:103], v3, s[32:35], s75 offen offset:1024 nt
    s_waitcnt vmcnt(30)
    v_perm_b32 v51, v140, v136, s62
    v_perm_b32 v55, v140, v136, s63
    v_perm_b32 v59, v141, v137, s62
    v_perm_b32 v63, v141, v137, s63
    v_perm_b32 v67, v142, v138, s62
    v_perm_b32 v71, v142, v138, s63
    v_perm_b32 v75, v143, v139, s62
    v_perm_b32 v79, v143, v139, s63
    buffer_load_dwordx4 v[104:107], v3, s[32:35], s75 offen offset:2048 nt
    buffer_load_dwordx4 v[108:111], v3, s[32:35], s75 offen offset:3072 nt
    v_mfma_f32_16x16x32_bf16 v[16:19], v[48:51], v[192:195], v[16:19]
    v_mfma_f32_16x16x32_bf16 v[20:23], v[52:55], v[192:195], v[20:23]
    v_mfma_f32_16x16x32_bf16 v[24:27], v[56:59], v[192:195], v[24:27]
    v_mfma_f32_16x16x32_bf16 v[28:31], v[60:63], v[192:195], v[28:31]
    v_mfma_f32_16x16x32_bf16 v[32:35], v[64:67], v[192:195], v[32:35]
    v_mfma_f32_16x16x32_bf16 v[36:39], v[68:71], v[192:195], v[36:39]
    v_mfma_f32_16x16x32_bf16 v[40:43], v[72:75], v[192:195], v[40:43]
    v_mfma_f32_16x16x32_bf16 v[44:47], v[76:79], v[192:195], v[44:47]
    s_add_u32 s74, s76, 14
    s_add_u32 s75, s76, 15
    s_and_b32 s74, s74, 15
    s_and_b32 s75, s75, 15
    s_lshl_b32 s74, s74, 12
    s_lshl_b32 s75, s75, 12
    s_waitcnt vmcnt(31)
    v_mfma_f32_16x16x32_bf16 v[48:51], a[64:67], v[4:7], 0
    buffer_load_dwordx4 a[32:35], v2, s[28:31], s74 offen offset:0 nt
    s_waitcnt vmcnt(31)
    v_mfma_f32_16x16x32_bf16 v[52:55], a[68:71], v[4:7], 0
    buffer_load_dwordx4 a[36:39], v2, s[28:31], s74 offen offset:1024 nt
    s_waitcnt vmcnt(31)
    v_mfma_f32_16x16x32_bf16 v[56:59], a[72:75], v[4:7], 0
    buffer_load_dwordx4 a[40:43], v2, s[28:31], s74 offen offset:2048 nt
    s_waitcnt vmcnt(31)
    v_mfma_f32_16x16x32_bf16 v[60:63], a[76:79], v[4:7], 0
    buffer_load_dwordx4 a[44:47], v2, s[28:31], s74 offen offset:3072 nt
    s_waitcnt vmcnt(31)
    v_mfma_f32_16x16x32_bf16 v[64:67], a[80:83], v[4:7], 0
    buffer_load_dwordx4 a[48:51], v2, s[28:31], s75 offen offset:0 nt
    s_waitcnt vmcnt(31)
    v_mfma_f32_16x16x32_bf16 v[68:71], a[84:87], v[4:7], 0
    buffer_load_dwordx4 a[52:55], v2, s[28:31], s75 offen offset:1024 nt
    s_waitcnt vmcnt(31)
    v_mfma_f32_16x16x32_bf16 v[72:75], a[88:91], v[4:7], 0
    buffer_load_dwordx4 a[56:59], v2, s[28:31], s75 offen offset:2048 nt
    s_waitcnt vmcnt(31)
    v_mfma_f32_16x16x32_bf16 v[76:79], a[92:95], v[4:7], 0
    buffer_load_dwordx4 a[60:63], v2, s[28:31], s75 offen offset:3072 nt
    v_mov_b32_dpp v176, v48 quad_perm:[0,0,0,0] row_mask:0xf bank_mask:0xf
    v_mov_b32_dpp v177, v52 quad_perm:[0,0,0,0] row_mask:0xf bank_mask:0xf
    v_mov_b32_dpp v178, v56 quad_perm:[0,0,0,0] row_mask:0xf bank_mask:0xf
    v_mov_b32_dpp v179, v60 quad_perm:[0,0,0,0] row_mask:0xf bank_mask:0xf
    v_mov_b32_dpp v180, v64 quad_perm:[0,0,0,0] row_mask:0xf bank_mask:0xf
    v_mov_b32_dpp v181, v68 quad_perm:[0,0,0,0] row_mask:0xf bank_mask:0xf
    v_mov_b32_dpp v182, v72 quad_perm:[0,0,0,0] row_mask:0xf bank_mask:0xf
    v_mov_b32_dpp v183, v76 quad_perm:[0,0,0,0] row_mask:0xf bank_mask:0xf
    v_add_f32_dpp v176, v49, v176 quad_perm:[1,1,1,1] row_mask:0xf bank_mask:0xf
    v_add_f32_dpp v177, v53, v177 quad_perm:[1,1,1,1] row_mask:0xf bank_mask:0xf
    v_add_f32_dpp v178, v57, v178 quad_perm:[1,1,1,1] row_mask:0xf bank_mask:0xf
    v_add_f32_dpp v179, v61, v179 quad_perm:[1,1,1,1] row_mask:0xf bank_mask:0xf
    v_add_f32_dpp v180, v65, v180 quad_perm:[1,1,1,1] row_mask:0xf bank_mask:0xf
    v_add_f32_dpp v181, v69, v181 quad_perm:[1,1,1,1] row_mask:0xf bank_mask:0xf
    v_add_f32_dpp v182, v73, v182 quad_perm:[1,1,1,1] row_mask:0xf bank_mask:0xf
    v_add_f32_dpp v183, v77, v183 quad_perm:[1,1,1,1] row_mask:0xf bank_mask:0xf
    v_add_f32_dpp v176, v50, v176 quad_perm:[2,2,2,2] row_mask:0xf bank_mask:0xf
    v_add_f32_dpp v177, v54, v177 quad_perm:[2,2,2,2] row_mask:0xf bank_mask:0xf
    v_add_f32_dpp v178, v58, v178 quad_perm:[2,2,2,2] row_mask:0xf bank_mask:0xf
    v_add_f32_dpp v179, v62, v179 quad_perm:[2,2,2,2] row_mask:0xf bank_mask:0xf
    v_add_f32_dpp v180, v66, v180 quad_perm:[2,2,2,2] row_mask:0xf bank_mask:0xf
    v_add_f32_dpp v181, v70, v181 quad_perm:[2,2,2,2] row_mask:0xf bank_mask:0xf
    v_add_f32_dpp v182, v74, v182 quad_perm:[2,2,2,2] row_mask:0xf bank_mask:0xf
    v_add_f32_dpp v183, v78, v183 quad_perm:[2,2,2,2] row_mask:0xf bank_mask:0xf
    v_add_f32_dpp v176, v51, v176 quad_perm:[3,3,3,3] row_mask:0xf bank_mask:0xf
    v_add_f32_dpp v177, v55, v177 quad_perm:[3,3,3,3] row_mask:0xf bank_mask:0xf
    v_add_f32_dpp v178, v59, v178 quad_perm:[3,3,3,3] row_mask:0xf bank_mask:0xf
    v_add_f32_dpp v179, v63, v179 quad_perm:[3,3,3,3] row_mask:0xf bank_mask:0xf
    v_add_f32_dpp v180, v67, v180 quad_perm:[3,3,3,3] row_mask:0xf bank_mask:0xf
    v_add_f32_dpp v181, v71, v181 quad_perm:[3,3,3,3] row_mask:0xf bank_mask:0xf
    v_add_f32_dpp v182, v75, v182 quad_perm:[3,3,3,3] row_mask:0xf bank_mask:0xf
    v_add_f32_dpp v183, v79, v183 quad_perm:[3,3,3,3] row_mask:0xf bank_mask:0xf
    v_cvt_pk_bf16_f32 v192, v176, v177
    v_cvt_pk_bf16_f32 v193, v178, v179
    v_cvt_pk_bf16_f32 v194, v180, v181
    v_cvt_pk_bf16_f32 v195, v182, v183
    v_lshlrev_b32 v184, 16, v192
    v_and_b32 v185, 0xffff0000, v192
    v_lshlrev_b32 v186, 16, v193
    v_and_b32 v187, 0xffff0000, v193
    v_lshlrev_b32 v188, 16, v194
    v_and_b32 v189, 0xffff0000, v194
    v_lshlrev_b32 v190, 16, v195
    v_and_b32 v191, 0xffff0000, v195
    v_pk_mul_f32 v[184:185], v[184:185], s[70:71]
    v_pk_mul_f32 v[186:187], v[186:187], s[70:71]
    v_pk_mul_f32 v[188:189], v[188:189], s[70:71]
    v_pk_mul_f32 v[190:191], v[190:191], s[70:71]
    v_cvt_pk_bf16_f32 v192, v184, v185
    v_cvt_pk_bf16_f32 v193, v186, v187
    v_cvt_pk_bf16_f32 v194, v188, v189
    v_cvt_pk_bf16_f32 v195, v190, v191
    v_lshlrev_b32 v176, 16, v192
    v_and_b32 v177, 0xffff0000, v192
    v_lshlrev_b32 v178, 16, v193
    v_and_b32 v179, 0xffff0000, v193
    v_lshlrev_b32 v180, 16, v194
    v_and_b32 v181, 0xffff0000, v194
    v_lshlrev_b32 v182, 16, v195
    v_and_b32 v183, 0xffff0000, v195
    v_max3_f32 v12, v176, v177, v178
    v_max3_f32 v13, v179, v180, v181
    v_max3_f32 v12, v12, v182, v183
    v_max_f32 v12, v12, v13
    v_mov_b32 v13, v12
    s_nop 1
    v_permlane16_swap_b32 v12, v13
    v_max_f32 v12, v12, v13
    v_mov_b32 v13, v12
    s_nop 1
    v_permlane32_swap_b32 v12, v13
    v_max_f32 v12, v12, v13
    v_max_f32 v12, v12, v8
    v_sub_f32 v10, v8, v12
    v_mul_f32 v10, s72, v10
    v_mov_b32 v8, v12
    v_mul_f32 v13, s72, v12
    v_exp_f32 v10, v10
    v_fma_f32 v184, v176, s72, -v13
    v_fma_f32 v185, v177, s72, -v13
    v_fma_f32 v186, v178, s72, -v13
    v_fma_f32 v187, v179, s72, -v13
    v_fma_f32 v188, v180, s72, -v13
    v_fma_f32 v189, v181, s72, -v13
    v_fma_f32 v190, v182, s72, -v13
    v_fma_f32 v191, v183, s72, -v13
    v_exp_f32 v184, v184
    v_exp_f32 v185, v185
    v_exp_f32 v186, v186
    v_exp_f32 v187, v187
    v_exp_f32 v188, v188
    v_exp_f32 v189, v189
    v_exp_f32 v190, v190
    v_exp_f32 v191, v191
    v_cvt_pk_bf16_f32 v192, v184, v185
    v_cvt_pk_bf16_f32 v193, v186, v187
    v_cvt_pk_bf16_f32 v194, v188, v189
    v_cvt_pk_bf16_f32 v195, v190, v191
    v_pk_add_f32 v[184:185], v[184:185], v[186:187]
    v_pk_add_f32 v[188:189], v[188:189], v[190:191]
    v_pk_add_f32 v[184:185], v[184:185], v[188:189]
    v_fma_f32 v9, v9, v10, v184
    v_add_f32 v9, v9, v185
    v_pk_mul_f32 v[16:17], v[16:17], v[10:11] op_sel_hi:[1,0]
    v_pk_mul_f32 v[18:19], v[18:19], v[10:11] op_sel_hi:[1,0]
    v_pk_mul_f32 v[20:21], v[20:21], v[10:11] op_sel_hi:[1,0]
    v_pk_mul_f32 v[22:23], v[22:23], v[10:11] op_sel_hi:[1,0]
    v_pk_mul_f32 v[24:25], v[24:25], v[10:11] op_sel_hi:[1,0]
    v_pk_mul_f32 v[26:27], v[26:27], v[10:11] op_sel_hi:[1,0]
    v_pk_mul_f32 v[28:29], v[28:29], v[10:11] op_sel_hi:[1,0]
    v_pk_mul_f32 v[30:31], v[30:31], v[10:11] op_sel_hi:[1,0]
    v_pk_mul_f32 v[32:33], v[32:33], v[10:11] op_sel_hi:[1,0]
    v_pk_mul_f32 v[34:35], v[34:35], v[10:11] op_sel_hi:[1,0]
    v_pk_mul_f32 v[36:37], v[36:37], v[10:11] op_sel_hi:[1,0]
    v_pk_mul_f32 v[38:39], v[38:39], v[10:11] op_sel_hi:[1,0]
    v_pk_mul_f32 v[40:41], v[40:41], v[10:11] op_sel_hi:[1,0]
    v_pk_mul_f32 v[42:43], v[42:43], v[10:11] op_sel_hi:[1,0]
    v_pk_mul_f32 v[44:45], v[44:45], v[10:11] op_sel_hi:[1,0]
    v_pk_mul_f32 v[46:47], v[46:47], v[10:11] op_sel_hi:[1,0]
    s_waitcnt vmcnt(30)
    v_perm_b32 v48, v148, v144, s62
    v_perm_b32 v52, v148, v144, s63
    v_perm_b32 v56, v149, v145, s62
    v_perm_b32 v60, v149, v145, s63
    v_perm_b32 v64, v150, v146, s62
    v_perm_b32 v68, v150, v146, s63
    v_perm_b32 v72, v151, v147, s62
    v_perm_b32 v76, v151, v147, s63
    buffer_load_dwordx4 v[112:115], v3, s[32:35], s74 offen offset:0 nt
    buffer_load_dwordx4 v[116:119], v3, s[32:35], s74 offen offset:1024 nt
    s_waitcnt vmcnt(30)
    v_perm_b32 v49, v156, v152, s62
    v_perm_b32 v53, v156, v152, s63
    v_perm_b32 v57, v157, v153, s62
    v_perm_b32 v61, v157, v153, s63
    v_perm_b32 v65, v158, v154, s62
    v_perm_b32 v69, v158, v154, s63
    v_perm_b32 v73, v159, v155, s62
    v_perm_b32 v77, v159, v155, s63
    buffer_load_dwordx4 v[120:123], v3, s[32:35], s74 offen offset:2048 nt
    buffer_load_dwordx4 v[124:127], v3, s[32:35], s74 offen offset:3072 nt
    s_waitcnt vmcnt(30)
    v_perm_b32 v50, v164, v160, s62
    v_perm_b32 v54, v164, v160, s63
    v_perm_b32 v58, v165, v161, s62
    v_perm_b32 v62, v165, v161, s63
    v_perm_b32 v66, v166, v162, s62
    v_perm_b32 v70, v166, v162, s63
    v_perm_b32 v74, v167, v163, s62
    v_perm_b32 v78, v167, v163, s63
    buffer_load_dwordx4 v[128:131], v3, s[32:35], s75 offen offset:0 nt
    buffer_load_dwordx4 v[132:135], v3, s[32:35], s75 offen offset:1024 nt
    s_waitcnt vmcnt(30)
    v_perm_b32 v51, v172, v168, s62
    v_perm_b32 v55, v172, v168, s63
    v_perm_b32 v59, v173, v169, s62
    v_perm_b32 v63, v173, v169, s63
    v_perm_b32 v67, v174, v170, s62
    v_perm_b32 v71, v174, v170, s63
    v_perm_b32 v75, v175, v171, s62
    v_perm_b32 v79, v175, v171, s63
    buffer_load_dwordx4 v[136:139], v3, s[32:35], s75 offen offset:2048 nt
    buffer_load_dwordx4 v[140:143], v3, s[32:35], s75 offen offset:3072 nt
    v_mfma_f32_16x16x32_bf16 v[16:19], v[48:51], v[192:195], v[16:19]
    v_mfma_f32_16x16x32_bf16 v[20:23], v[52:55], v[192:195], v[20:23]
    v_mfma_f32_16x16x32_bf16 v[24:27], v[56:59], v[192:195], v[24:27]
    v_mfma_f32_16x16x32_bf16 v[28:31], v[60:63], v[192:195], v[28:31]
    v_mfma_f32_16x16x32_bf16 v[32:35], v[64:67], v[192:195], v[32:35]
    v_mfma_f32_16x16x32_bf16 v[36:39], v[68:71], v[192:195], v[36:39]
    v_mfma_f32_16x16x32_bf16 v[40:43], v[72:75], v[192:195], v[40:43]
    v_mfma_f32_16x16x32_bf16 v[44:47], v[76:79], v[192:195], v[44:47]
    s_barrier
    s_waitcnt vmcnt(31)
    v_mfma_f32_16x16x32_bf16 v[48:51], a[0:3], v[4:7], 0
    s_waitcnt vmcnt(30)
    v_mfma_f32_16x16x32_bf16 v[52:55], a[4:7], v[4:7], 0
    s_waitcnt vmcnt(29)
    v_mfma_f32_16x16x32_bf16 v[56:59], a[8:11], v[4:7], 0
    s_waitcnt vmcnt(28)
    v_mfma_f32_16x16x32_bf16 v[60:63], a[12:15], v[4:7], 0
    s_waitcnt vmcnt(27)
    v_mfma_f32_16x16x32_bf16 v[64:67], a[16:19], v[4:7], 0
    s_waitcnt vmcnt(26)
    v_mfma_f32_16x16x32_bf16 v[68:71], a[20:23], v[4:7], 0
    s_waitcnt vmcnt(25)
    v_mfma_f32_16x16x32_bf16 v[72:75], a[24:27], v[4:7], 0
    s_waitcnt vmcnt(24)
    v_mfma_f32_16x16x32_bf16 v[76:79], a[28:31], v[4:7], 0
    v_mov_b32_dpp v176, v48 quad_perm:[0,0,0,0] row_mask:0xf bank_mask:0xf
    v_mov_b32_dpp v177, v52 quad_perm:[0,0,0,0] row_mask:0xf bank_mask:0xf
    v_mov_b32_dpp v178, v56 quad_perm:[0,0,0,0] row_mask:0xf bank_mask:0xf
    v_mov_b32_dpp v179, v60 quad_perm:[0,0,0,0] row_mask:0xf bank_mask:0xf
    v_mov_b32_dpp v180, v64 quad_perm:[0,0,0,0] row_mask:0xf bank_mask:0xf
    v_mov_b32_dpp v181, v68 quad_perm:[0,0,0,0] row_mask:0xf bank_mask:0xf
    v_mov_b32_dpp v182, v72 quad_perm:[0,0,0,0] row_mask:0xf bank_mask:0xf
    s_nop 0
    v_mov_b32_dpp v183, v76 quad_perm:[0,0,0,0] row_mask:0xf bank_mask:0xf
    v_add_f32_dpp v176, v49, v176 quad_perm:[1,1,1,1] row_mask:0xf bank_mask:0xf
    v_add_f32_dpp v177, v53, v177 quad_perm:[1,1,1,1] row_mask:0xf bank_mask:0xf
    v_add_f32_dpp v178, v57, v178 quad_perm:[1,1,1,1] row_mask:0xf bank_mask:0xf
    v_add_f32_dpp v179, v61, v179 quad_perm:[1,1,1,1] row_mask:0xf bank_mask:0xf
    v_add_f32_dpp v180, v65, v180 quad_perm:[1,1,1,1] row_mask:0xf bank_mask:0xf
    v_add_f32_dpp v181, v69, v181 quad_perm:[1,1,1,1] row_mask:0xf bank_mask:0xf
    v_add_f32_dpp v182, v73, v182 quad_perm:[1,1,1,1] row_mask:0xf bank_mask:0xf
    v_add_f32_dpp v183, v77, v183 quad_perm:[1,1,1,1] row_mask:0xf bank_mask:0xf
    v_add_f32_dpp v176, v50, v176 quad_perm:[2,2,2,2] row_mask:0xf bank_mask:0xf
    v_add_f32_dpp v177, v54, v177 quad_perm:[2,2,2,2] row_mask:0xf bank_mask:0xf
    v_add_f32_dpp v178, v58, v178 quad_perm:[2,2,2,2] row_mask:0xf bank_mask:0xf
    v_add_f32_dpp v179, v62, v179 quad_perm:[2,2,2,2] row_mask:0xf bank_mask:0xf
    v_add_f32_dpp v180, v66, v180 quad_perm:[2,2,2,2] row_mask:0xf bank_mask:0xf
    v_add_f32_dpp v181, v70, v181 quad_perm:[2,2,2,2] row_mask:0xf bank_mask:0xf
    v_add_f32_dpp v182, v74, v182 quad_perm:[2,2,2,2] row_mask:0xf bank_mask:0xf
    v_add_f32_dpp v183, v78, v183 quad_perm:[2,2,2,2] row_mask:0xf bank_mask:0xf
    v_add_f32_dpp v176, v51, v176 quad_perm:[3,3,3,3] row_mask:0xf bank_mask:0xf
    v_add_f32_dpp v177, v55, v177 quad_perm:[3,3,3,3] row_mask:0xf bank_mask:0xf
    v_add_f32_dpp v178, v59, v178 quad_perm:[3,3,3,3] row_mask:0xf bank_mask:0xf
    v_add_f32_dpp v179, v63, v179 quad_perm:[3,3,3,3] row_mask:0xf bank_mask:0xf
    v_add_f32_dpp v180, v67, v180 quad_perm:[3,3,3,3] row_mask:0xf bank_mask:0xf
    v_add_f32_dpp v181, v71, v181 quad_perm:[3,3,3,3] row_mask:0xf bank_mask:0xf
    v_add_f32_dpp v182, v75, v182 quad_perm:[3,3,3,3] row_mask:0xf bank_mask:0xf
    v_add_f32_dpp v183, v79, v183 quad_perm:[3,3,3,3] row_mask:0xf bank_mask:0xf
    v_cvt_pk_bf16_f32 v192, v176, v177
    v_cvt_pk_bf16_f32 v193, v178, v179
    v_cvt_pk_bf16_f32 v194, v180, v181
    v_cvt_pk_bf16_f32 v195, v182, v183
    v_lshlrev_b32 v184, 16, v192
    v_and_b32 v185, 0xffff0000, v192
    v_lshlrev_b32 v186, 16, v193
    v_and_b32 v187, 0xffff0000, v193
    v_lshlrev_b32 v188, 16, v194
    v_and_b32 v189, 0xffff0000, v194
    v_lshlrev_b32 v190, 16, v195
    v_and_b32 v191, 0xffff0000, v195
    v_pk_mul_f32 v[184:185], v[184:185], s[70:71]
    v_pk_mul_f32 v[186:187], v[186:187], s[70:71]
    v_pk_mul_f32 v[188:189], v[188:189], s[70:71]
    v_pk_mul_f32 v[190:191], v[190:191], s[70:71]
    v_cvt_pk_bf16_f32 v192, v184, v185
    v_cvt_pk_bf16_f32 v193, v186, v187
    v_cvt_pk_bf16_f32 v194, v188, v189
    v_cvt_pk_bf16_f32 v195, v190, v191
    v_lshlrev_b32 v176, 16, v192
    v_and_b32 v177, 0xffff0000, v192
    v_lshlrev_b32 v178, 16, v193
    v_and_b32 v179, 0xffff0000, v193
    v_lshlrev_b32 v180, 16, v194
    v_and_b32 v181, 0xffff0000, v194
    v_lshlrev_b32 v182, 16, v195
    v_and_b32 v183, 0xffff0000, v195
    v_max3_f32 v12, v176, v177, v178
    v_max3_f32 v13, v179, v180, v181
    v_max3_f32 v12, v12, v182, v183
    v_max_f32 v12, v12, v13
    v_mov_b32 v13, v12
    s_nop 1
    v_permlane16_swap_b32 v12, v13
    v_max_f32 v12, v12, v13
    v_mov_b32 v13, v12
    s_nop 1
    v_permlane32_swap_b32 v12, v13
    v_max_f32 v12, v12, v13
    v_max_f32 v12, v12, v8
    v_sub_f32 v10, v8, v12
    v_mul_f32 v10, s72, v10
    v_mov_b32 v8, v12
    v_mul_f32 v13, s72, v12
    v_exp_f32 v10, v10
    v_fma_f32 v184, v176, s72, -v13
    v_fma_f32 v185, v177, s72, -v13
    v_fma_f32 v186, v178, s72, -v13
    v_fma_f32 v187, v179, s72, -v13
    v_fma_f32 v188, v180, s72, -v13
    v_fma_f32 v189, v181, s72, -v13
    v_fma_f32 v190, v182, s72, -v13
    v_fma_f32 v191, v183, s72, -v13
    v_exp_f32 v184, v184
    v_exp_f32 v185, v185
    v_exp_f32 v186, v186
    v_exp_f32 v187, v187
    v_exp_f32 v188, v188
    v_exp_f32 v189, v189
    v_exp_f32 v190, v190
    v_exp_f32 v191, v191
    v_cvt_pk_bf16_f32 v192, v184, v185
    v_cvt_pk_bf16_f32 v193, v186, v187
    v_cvt_pk_bf16_f32 v194, v188, v189
    v_cvt_pk_bf16_f32 v195, v190, v191
    v_pk_add_f32 v[184:185], v[184:185], v[186:187]
    v_pk_add_f32 v[188:189], v[188:189], v[190:191]
    v_pk_add_f32 v[184:185], v[184:185], v[188:189]
    v_fma_f32 v9, v9, v10, v184
    v_add_f32 v9, v9, v185
    v_pk_mul_f32 v[16:17], v[16:17], v[10:11] op_sel_hi:[1,0]
    v_pk_mul_f32 v[18:19], v[18:19], v[10:11] op_sel_hi:[1,0]
    v_pk_mul_f32 v[20:21], v[20:21], v[10:11] op_sel_hi:[1,0]
    v_pk_mul_f32 v[22:23], v[22:23], v[10:11] op_sel_hi:[1,0]
    v_pk_mul_f32 v[24:25], v[24:25], v[10:11] op_sel_hi:[1,0]
    v_pk_mul_f32 v[26:27], v[26:27], v[10:11] op_sel_hi:[1,0]
    v_pk_mul_f32 v[28:29], v[28:29], v[10:11] op_sel_hi:[1,0]
    v_pk_mul_f32 v[30:31], v[30:31], v[10:11] op_sel_hi:[1,0]
    v_pk_mul_f32 v[32:33], v[32:33], v[10:11] op_sel_hi:[1,0]
    v_pk_mul_f32 v[34:35], v[34:35], v[10:11] op_sel_hi:[1,0]
    v_pk_mul_f32 v[36:37], v[36:37], v[10:11] op_sel_hi:[1,0]
    v_pk_mul_f32 v[38:39], v[38:39], v[10:11] op_sel_hi:[1,0]
    v_pk_mul_f32 v[40:41], v[40:41], v[10:11] op_sel_hi:[1,0]
    v_pk_mul_f32 v[42:43], v[42:43], v[10:11] op_sel_hi:[1,0]
    v_pk_mul_f32 v[44:45], v[44:45], v[10:11] op_sel_hi:[1,0]
    v_pk_mul_f32 v[46:47], v[46:47], v[10:11] op_sel_hi:[1,0]
    s_waitcnt vmcnt(22)
    v_perm_b32 v48, v84, v80, s62
    v_perm_b32 v52, v84, v80, s63
    v_perm_b32 v56, v85, v81, s62
    v_perm_b32 v60, v85, v81, s63
    v_perm_b32 v64, v86, v82, s62
    v_perm_b32 v68, v86, v82, s63
    v_perm_b32 v72, v87, v83, s62
    v_perm_b32 v76, v87, v83, s63
    s_waitcnt vmcnt(20)
    v_perm_b32 v49, v92, v88, s62
    v_perm_b32 v53, v92, v88, s63
    v_perm_b32 v57, v93, v89, s62
    v_perm_b32 v61, v93, v89, s63
    v_perm_b32 v65, v94, v90, s62
    v_perm_b32 v69, v94, v90, s63
    v_perm_b32 v73, v95, v91, s62
    v_perm_b32 v77, v95, v91, s63
    s_waitcnt vmcnt(18)
    v_perm_b32 v50, v100, v96, s62
    v_perm_b32 v54, v100, v96, s63
    v_perm_b32 v58, v101, v97, s62
    v_perm_b32 v62, v101, v97, s63
    v_perm_b32 v66, v102, v98, s62
    v_perm_b32 v70, v102, v98, s63
    v_perm_b32 v74, v103, v99, s62
    v_perm_b32 v78, v103, v99, s63
    s_waitcnt vmcnt(16)
    v_perm_b32 v51, v108, v104, s62
    v_perm_b32 v55, v108, v104, s63
    v_perm_b32 v59, v109, v105, s62
    v_perm_b32 v63, v109, v105, s63
    v_perm_b32 v67, v110, v106, s62
    v_perm_b32 v71, v110, v106, s63
    v_perm_b32 v75, v111, v107, s62
    v_perm_b32 v79, v111, v107, s63
    v_mfma_f32_16x16x32_bf16 v[16:19], v[48:51], v[192:195], v[16:19]
    v_mfma_f32_16x16x32_bf16 v[20:23], v[52:55], v[192:195], v[20:23]
    v_mfma_f32_16x16x32_bf16 v[24:27], v[56:59], v[192:195], v[24:27]
    v_mfma_f32_16x16x32_bf16 v[28:31], v[60:63], v[192:195], v[28:31]
    v_mfma_f32_16x16x32_bf16 v[32:35], v[64:67], v[192:195], v[32:35]
    v_mfma_f32_16x16x32_bf16 v[36:39], v[68:71], v[192:195], v[36:39]
    v_mfma_f32_16x16x32_bf16 v[40:43], v[72:75], v[192:195], v[40:43]
    v_mfma_f32_16x16x32_bf16 v[44:47], v[76:79], v[192:195], v[44:47]
    s_waitcnt vmcnt(15)
    v_mfma_f32_16x16x32_bf16 v[48:51], a[32:35], v[4:7], 0
    s_waitcnt vmcnt(14)
    v_mfma_f32_16x16x32_bf16 v[52:55], a[36:39], v[4:7], 0
    s_waitcnt vmcnt(13)
    v_mfma_f32_16x16x32_bf16 v[56:59], a[40:43], v[4:7], 0
    s_waitcnt vmcnt(12)
    v_mfma_f32_16x16x32_bf16 v[60:63], a[44:47], v[4:7], 0
    s_waitcnt vmcnt(11)
    v_mfma_f32_16x16x32_bf16 v[64:67], a[48:51], v[4:7], 0
    s_waitcnt vmcnt(10)
    v_mfma_f32_16x16x32_bf16 v[68:71], a[52:55], v[4:7], 0
    s_waitcnt vmcnt(9)
    v_mfma_f32_16x16x32_bf16 v[72:75], a[56:59], v[4:7], 0
    s_waitcnt vmcnt(8)
    v_mfma_f32_16x16x32_bf16 v[76:79], a[60:63], v[4:7], 0
    buffer_load_dwordx4 v[144:147], v254, s[40:43], s81 offen offset:0 nt
    buffer_load_dwordx4 v[148:151], v254, s[40:43], s81 offen offset:1024 nt
    buffer_load_dwordx4 v[152:155], v254, s[40:43], s81 offen offset:2048 nt
    buffer_load_dwordx4 v[156:159], v254, s[40:43], s81 offen offset:3072 nt
    buffer_load_dwordx4 v[160:163], v254, s[40:43], s80 offen offset:0 nt
    buffer_load_dwordx4 v[164:167], v254, s[40:43], s80 offen offset:1024 nt
    buffer_load_dwordx4 v[168:171], v254, s[40:43], s80 offen offset:2048 nt
    buffer_load_dwordx4 v[172:175], v254, s[40:43], s80 offen offset:3072 nt
    buffer_load_dword v252, v238, s[36:39], 0 offen sc1
    v_mov_b32_dpp v176, v48 quad_perm:[0,0,0,0] row_mask:0xf bank_mask:0xf
    v_mov_b32_dpp v177, v52 quad_perm:[0,0,0,0] row_mask:0xf bank_mask:0xf
    v_mov_b32_dpp v178, v56 quad_perm:[0,0,0,0] row_mask:0xf bank_mask:0xf
    v_mov_b32_dpp v179, v60 quad_perm:[0,0,0,0] row_mask:0xf bank_mask:0xf
    v_mov_b32_dpp v180, v64 quad_perm:[0,0,0,0] row_mask:0xf bank_mask:0xf
    v_mov_b32_dpp v181, v68 quad_perm:[0,0,0,0] row_mask:0xf bank_mask:0xf
    v_mov_b32_dpp v182, v72 quad_perm:[0,0,0,0] row_mask:0xf bank_mask:0xf
    v_mov_b32_dpp v183, v76 quad_perm:[0,0,0,0] row_mask:0xf bank_mask:0xf
    v_add_f32_dpp v176, v49, v176 quad_perm:[1,1,1,1] row_mask:0xf bank_mask:0xf
    v_add_f32_dpp v177, v53, v177 quad_perm:[1,1,1,1] row_mask:0xf bank_mask:0xf
    v_add_f32_dpp v178, v57, v178 quad_perm:[1,1,1,1] row_mask:0xf bank_mask:0xf
    v_add_f32_dpp v179, v61, v179 quad_perm:[1,1,1,1] row_mask:0xf bank_mask:0xf
    v_add_f32_dpp v180, v65, v180 quad_perm:[1,1,1,1] row_mask:0xf bank_mask:0xf
    v_add_f32_dpp v181, v69, v181 quad_perm:[1,1,1,1] row_mask:0xf bank_mask:0xf
    v_add_f32_dpp v182, v73, v182 quad_perm:[1,1,1,1] row_mask:0xf bank_mask:0xf
    v_add_f32_dpp v183, v77, v183 quad_perm:[1,1,1,1] row_mask:0xf bank_mask:0xf
    v_add_f32_dpp v176, v50, v176 quad_perm:[2,2,2,2] row_mask:0xf bank_mask:0xf
    v_add_f32_dpp v177, v54, v177 quad_perm:[2,2,2,2] row_mask:0xf bank_mask:0xf
    v_add_f32_dpp v178, v58, v178 quad_perm:[2,2,2,2] row_mask:0xf bank_mask:0xf
    v_add_f32_dpp v179, v62, v179 quad_perm:[2,2,2,2] row_mask:0xf bank_mask:0xf
    v_add_f32_dpp v180, v66, v180 quad_perm:[2,2,2,2] row_mask:0xf bank_mask:0xf
    v_add_f32_dpp v181, v70, v181 quad_perm:[2,2,2,2] row_mask:0xf bank_mask:0xf
    v_add_f32_dpp v182, v74, v182 quad_perm:[2,2,2,2] row_mask:0xf bank_mask:0xf
    v_add_f32_dpp v183, v78, v183 quad_perm:[2,2,2,2] row_mask:0xf bank_mask:0xf
    v_add_f32_dpp v176, v51, v176 quad_perm:[3,3,3,3] row_mask:0xf bank_mask:0xf
    v_add_f32_dpp v177, v55, v177 quad_perm:[3,3,3,3] row_mask:0xf bank_mask:0xf
    v_add_f32_dpp v178, v59, v178 quad_perm:[3,3,3,3] row_mask:0xf bank_mask:0xf
    v_add_f32_dpp v179, v63, v179 quad_perm:[3,3,3,3] row_mask:0xf bank_mask:0xf
    v_add_f32_dpp v180, v67, v180 quad_perm:[3,3,3,3] row_mask:0xf bank_mask:0xf
    v_add_f32_dpp v181, v71, v181 quad_perm:[3,3,3,3] row_mask:0xf bank_mask:0xf
    v_add_f32_dpp v182, v75, v182 quad_perm:[3,3,3,3] row_mask:0xf bank_mask:0xf
    v_add_f32_dpp v183, v79, v183 quad_perm:[3,3,3,3] row_mask:0xf bank_mask:0xf
    v_cvt_pk_bf16_f32 v192, v176, v177
    v_cvt_pk_bf16_f32 v193, v178, v179
    v_cvt_pk_bf16_f32 v194, v180, v181
    v_cvt_pk_bf16_f32 v195, v182, v183
    v_lshlrev_b32 v184, 16, v192
    v_and_b32 v185, 0xffff0000, v192
    v_lshlrev_b32 v186, 16, v193
    v_and_b32 v187, 0xffff0000, v193
    v_lshlrev_b32 v188, 16, v194
    v_and_b32 v189, 0xffff0000, v194
    v_lshlrev_b32 v190, 16, v195
    v_and_b32 v191, 0xffff0000, v195
    v_pk_mul_f32 v[184:185], v[184:185], s[70:71]
    v_pk_mul_f32 v[186:187], v[186:187], s[70:71]
    v_pk_mul_f32 v[188:189], v[188:189], s[70:71]
    v_pk_mul_f32 v[190:191], v[190:191], s[70:71]
    v_cvt_pk_bf16_f32 v192, v184, v185
    v_cvt_pk_bf16_f32 v193, v186, v187
    v_cvt_pk_bf16_f32 v194, v188, v189
    v_cvt_pk_bf16_f32 v195, v190, v191
    v_lshlrev_b32 v176, 16, v192
    v_and_b32 v177, 0xffff0000, v192
    v_lshlrev_b32 v178, 16, v193
    v_and_b32 v179, 0xffff0000, v193
    v_lshlrev_b32 v180, 16, v194
    v_and_b32 v181, 0xffff0000, v194
    v_lshlrev_b32 v182, 16, v195
    v_and_b32 v183, 0xffff0000, v195
    v_max3_f32 v12, v176, v177, v178
    v_max3_f32 v13, v179, v180, v181
    v_max3_f32 v12, v12, v182, v183
    v_max_f32 v12, v12, v13
    v_mov_b32 v13, v12
    s_nop 1
    v_permlane16_swap_b32 v12, v13
    v_max_f32 v12, v12, v13
    v_mov_b32 v13, v12
    s_nop 1
    v_permlane32_swap_b32 v12, v13
    v_max_f32 v12, v12, v13
    v_max_f32 v12, v12, v8
    s_mov_b64 exec, 0x1111
    ds_write_b32 v243, v12 offset:55296
    s_mov_b64 exec, -1
    s_waitcnt lgkmcnt(0)
    s_barrier
    ds_read_b128 v[184:187], v244 offset:55296
    s_waitcnt lgkmcnt(0)
    v_max3_f32 v12, v184, v185, v186
    v_max_f32 v12, v12, v187
    v_sub_f32 v10, v8, v12
    v_mul_f32 v10, s72, v10
    v_mov_b32 v8, v12
    v_mul_f32 v13, s72, v12
    v_exp_f32 v10, v10
    v_fma_f32 v184, v176, s72, -v13
    v_fma_f32 v185, v177, s72, -v13
    v_fma_f32 v186, v178, s72, -v13
    v_fma_f32 v187, v179, s72, -v13
    v_fma_f32 v188, v180, s72, -v13
    v_fma_f32 v189, v181, s72, -v13
    v_fma_f32 v190, v182, s72, -v13
    v_fma_f32 v191, v183, s72, -v13
    v_exp_f32 v184, v184
    v_exp_f32 v185, v185
    v_exp_f32 v186, v186
    v_exp_f32 v187, v187
    v_exp_f32 v188, v188
    v_exp_f32 v189, v189
    v_exp_f32 v190, v190
    v_exp_f32 v191, v191
    v_cvt_pk_bf16_f32 v192, v184, v185
    v_cvt_pk_bf16_f32 v193, v186, v187
    v_cvt_pk_bf16_f32 v194, v188, v189
    v_cvt_pk_bf16_f32 v195, v190, v191
    v_pk_add_f32 v[184:185], v[184:185], v[186:187]
    v_pk_add_f32 v[188:189], v[188:189], v[190:191]
    v_pk_add_f32 v[184:185], v[184:185], v[188:189]
    v_fma_f32 v9, v9, v10, v184
    v_add_f32 v9, v9, v185
    v_pk_mul_f32 v[16:17], v[16:17], v[10:11] op_sel_hi:[1,0]
    v_pk_mul_f32 v[18:19], v[18:19], v[10:11] op_sel_hi:[1,0]
    v_pk_mul_f32 v[20:21], v[20:21], v[10:11] op_sel_hi:[1,0]
    v_pk_mul_f32 v[22:23], v[22:23], v[10:11] op_sel_hi:[1,0]
    v_pk_mul_f32 v[24:25], v[24:25], v[10:11] op_sel_hi:[1,0]
    v_pk_mul_f32 v[26:27], v[26:27], v[10:11] op_sel_hi:[1,0]
    v_pk_mul_f32 v[28:29], v[28:29], v[10:11] op_sel_hi:[1,0]
    v_pk_mul_f32 v[30:31], v[30:31], v[10:11] op_sel_hi:[1,0]
    v_pk_mul_f32 v[32:33], v[32:33], v[10:11] op_sel_hi:[1,0]
    v_pk_mul_f32 v[34:35], v[34:35], v[10:11] op_sel_hi:[1,0]
    v_pk_mul_f32 v[36:37], v[36:37], v[10:11] op_sel_hi:[1,0]
    v_pk_mul_f32 v[38:39], v[38:39], v[10:11] op_sel_hi:[1,0]
    v_pk_mul_f32 v[40:41], v[40:41], v[10:11] op_sel_hi:[1,0]
    v_pk_mul_f32 v[42:43], v[42:43], v[10:11] op_sel_hi:[1,0]
    v_pk_mul_f32 v[44:45], v[44:45], v[10:11] op_sel_hi:[1,0]
    v_pk_mul_f32 v[46:47], v[46:47], v[10:11] op_sel_hi:[1,0]
    v_mov_b32 v12, v9
    s_nop 1
    v_permlane16_swap_b32 v9, v12
    v_add_f32 v9, v9, v12
    v_mov_b32 v12, v9
    s_nop 1
    v_permlane32_swap_b32 v9, v12
    v_add_f32 v9, v9, v12
    s_mov_b64 exec, 0x1111
    ds_write_b32 v243, v9 offset:55360
    s_mov_b64 exec, -1
    s_waitcnt vmcnt(15)
    v_perm_b32 v48, v116, v112, s62
    v_perm_b32 v52, v116, v112, s63
    v_perm_b32 v56, v117, v113, s62
    v_perm_b32 v60, v117, v113, s63
    v_perm_b32 v64, v118, v114, s62
    v_perm_b32 v68, v118, v114, s63
    v_perm_b32 v72, v119, v115, s62
    v_perm_b32 v76, v119, v115, s63
    s_waitcnt vmcnt(13)
    v_perm_b32 v49, v124, v120, s62
    v_perm_b32 v53, v124, v120, s63
    v_perm_b32 v57, v125, v121, s62
    v_perm_b32 v61, v125, v121, s63
    v_perm_b32 v65, v126, v122, s62
    v_perm_b32 v69, v126, v122, s63
    v_perm_b32 v73, v127, v123, s62
    v_perm_b32 v77, v127, v123, s63
    s_waitcnt vmcnt(11)
    v_perm_b32 v50, v132, v128, s62
    v_perm_b32 v54, v132, v128, s63
    v_perm_b32 v58, v133, v129, s62
    v_perm_b32 v62, v133, v129, s63
    v_perm_b32 v66, v134, v130, s62
    v_perm_b32 v70, v134, v130, s63
    v_perm_b32 v74, v135, v131, s62
    v_perm_b32 v78, v135, v131, s63
    s_waitcnt vmcnt(9)
    v_perm_b32 v51, v140, v136, s62
    v_perm_b32 v55, v140, v136, s63
    v_perm_b32 v59, v141, v137, s62
    v_perm_b32 v63, v141, v137, s63
    v_perm_b32 v67, v142, v138, s62
    v_perm_b32 v71, v142, v138, s63
    v_perm_b32 v75, v143, v139, s62
    v_perm_b32 v79, v143, v139, s63
    v_mfma_f32_16x16x32_bf16 v[16:19], v[48:51], v[192:195], v[16:19]
    v_mfma_f32_16x16x32_bf16 v[20:23], v[52:55], v[192:195], v[20:23]
    v_mfma_f32_16x16x32_bf16 v[24:27], v[56:59], v[192:195], v[24:27]
    v_mfma_f32_16x16x32_bf16 v[28:31], v[60:63], v[192:195], v[28:31]
    v_mfma_f32_16x16x32_bf16 v[32:35], v[64:67], v[192:195], v[32:35]
    v_mfma_f32_16x16x32_bf16 v[36:39], v[68:71], v[192:195], v[36:39]
    v_mfma_f32_16x16x32_bf16 v[40:43], v[72:75], v[192:195], v[40:43]
    v_mfma_f32_16x16x32_bf16 v[44:47], v[76:79], v[192:195], v[44:47]
L_tail0:
    s_mov_b32 s84, 0x11111111
    s_mov_b32 s85, 0x11111111
    s_mov_b64 exec, s[84:85]
    ds_write_b128 v242, v[16:19] offset:47104
    ds_write_b128 v242, v[20:23] offset:47120
    ds_write_b128 v242, v[24:27] offset:47136
    ds_write_b128 v242, v[28:31] offset:47152
    ds_write_b128 v242, v[32:35] offset:47168
    ds_write_b128 v242, v[36:39] offset:47184
    ds_write_b128 v242, v[40:43] offset:47200
    ds_write_b128 v242, v[44:47] offset:47216
    s_mov_b64 exec, -1
    s_waitcnt lgkmcnt(0)
    s_barrier
    s_cmp_ge_u32 s58, 2
    s_cbranch_scc1 L_nocomb_16
    ds_read_b128 v[80:83], v245 offset:47104
    ds_read_b128 v[84:87], v245 offset:49152
    ds_read_b128 v[88:91], v245 offset:51200
    ds_read_b128 v[92:95], v245 offset:53248
    ds_read_b128 v[96:99], v246 offset:55296
    ds_read_b128 v[100:103], v246 offset:55360
    s_waitcnt lgkmcnt(4)
    v_pk_add_f32 v[80:81], v[80:81], v[84:85]
    v_pk_add_f32 v[82:83], v[82:83], v[86:87]
    s_waitcnt lgkmcnt(2)
    v_pk_add_f32 v[88:89], v[88:89], v[92:93]
    v_pk_add_f32 v[90:91], v[90:91], v[94:95]
    v_pk_add_f32 v[80:81], v[80:81], v[88:89]
    v_pk_add_f32 v[82:83], v[82:83], v[90:91]
    v_perm_b32 v104, v80, v196, s64
    v_perm_b32 v105, v81, v196, s65
    v_perm_b32 v106, v82, v196, s66
    v_perm_b32 v107, v83, v196, s67
    s_waitcnt lgkmcnt(0)
    v_max3_f32 v96, v96, v97, v98
    v_pk_add_f32 v[100:101], v[100:101], v[102:103]
    v_max_f32 v96, v96, v99
    v_add_f32 v100, v100, v101
    v_perm_b32 v108, v96, v196, s64
    v_perm_b32 v109, v100, v196, s65
    v_perm_b32 v110, v96, v196, s66
    v_perm_b32 v111, v100, v196, s67
    s_cmp_eq_u32 s77, 0
    s_cbranch_scc1 L_m1_17
    buffer_store_dwordx4 v[104:107], v245, s[36:39], s14 offen
    s_mov_b32 s84, 1
    s_mov_b32 s85, 1
    s_mov_b64 exec, s[84:85]
    buffer_store_dwordx4 v[108:111], v246, s[36:39], s15 offen
    s_mov_b64 exec, -1
    s_branch L_m2_18
L_m1_17:
    buffer_store_dwordx4 v[104:107], v245, s[36:39], s14 offen sc1
    s_mov_b32 s84, 1
    s_mov_b32 s85, 1
    s_mov_b64 exec, s[84:85]
    buffer_store_dwordx4 v[108:111], v246, s[36:39], s15 offen sc1
    s_mov_b64 exec, -1
L_m2_18:
L_nocomb_16:
    s_cmp_ge_u32 s58, 2
    s_cbranch_scc1 L_h1skip_19
    s_waitcnt vmcnt(3)
    v_perm_b32 v80, v148, v144, s62
    v_perm_b32 v84, v148, v144, s63
    v_perm_b32 v88, v149, v145, s62
    v_perm_b32 v92, v149, v145, s63
    v_perm_b32 v96, v150, v146, s62
    v_perm_b32 v100, v150, v146, s63
    v_perm_b32 v104, v151, v147, s62
    v_perm_b32 v108, v151, v147, s63
    v_perm_b32 v81, v156, v152, s62
    v_perm_b32 v85, v156, v152, s63
    v_perm_b32 v89, v157, v153, s62
    v_perm_b32 v93, v157, v153, s63
    v_perm_b32 v97, v158, v154, s62
    v_perm_b32 v101, v158, v154, s63
    v_perm_b32 v105, v159, v155, s62
    v_perm_b32 v109, v159, v155, s63
    v_perm_b32 v82, v164, v160, s62
    v_perm_b32 v86, v164, v160, s63
    v_perm_b32 v90, v165, v161, s62
    v_perm_b32 v94, v165, v161, s63
    v_perm_b32 v98, v166, v162, s62
    v_perm_b32 v102, v166, v162, s63
    v_perm_b32 v106, v167, v163, s62
    v_perm_b32 v110, v167, v163, s63
    v_perm_b32 v83, v172, v168, s62
    v_perm_b32 v87, v172, v168, s63
    v_perm_b32 v91, v173, v169, s62
    v_perm_b32 v95, v173, v169, s63
    v_perm_b32 v99, v174, v170, s62
    v_perm_b32 v103, v174, v170, s63
    v_perm_b32 v107, v175, v171, s62
    v_perm_b32 v111, v175, v171, s63
    s_mov_b32 s73, 0
L_h1_21:
    buffer_load_dwordx4 v[16:19], v230, s[36:39], s4 offen sc1
    buffer_load_dwordx4 v[20:23], v230, s[36:39], s5 offen sc1
    buffer_load_dwordx4 v[24:27], v231, s[36:39], s6 offen sc1
    buffer_load_dwordx4 v[28:31], v231, s[36:39], s7 offen sc1
    s_waitcnt vmcnt(0)
    v_xor_b32 v16, s68, v16
    v_xor_b32 v17, s69, v17
    v_xor_b32 v18, s3, v18
    v_xor_b32 v19, s27, v19
    v_or_b32 v14, v16, v17
    v_or3_b32 v14, v14, v18, v19
    v_xor_b32 v20, s68, v20
    v_xor_b32 v21, s69, v21
    v_xor_b32 v22, s3, v22
    v_xor_b32 v23, s27, v23
    v_or3_b32 v14, v14, v20, v21
    v_or3_b32 v14, v14, v22, v23
    v_xor_b32 v24, s68, v24
    v_xor_b32 v25, s69, v25
    v_xor_b32 v26, s3, v26
    v_xor_b32 v27, s27, v27
    v_or3_b32 v14, v14, v24, v25
    v_or3_b32 v14, v14, v26, v27
    v_xor_b32 v28, s68, v28
    v_xor_b32 v29, s69, v29
    v_xor_b32 v30, s3, v30
    v_xor_b32 v31, s27, v31
    v_or3_b32 v14, v14, v28, v29
    v_or3_b32 v14, v14, v30, v31
    v_and_b32 v14, 0xff, v14
    v_cmp_ne_u32 vcc, 0, v14
    s_nop 0
    s_cmp_eq_u64 vcc, 0
    s_cbranch_scc1 L_h1ok_20
    s_add_u32 s73, s73, 1
    s_cmp_lt_u32 s73, 100000
    s_cbranch_scc1 L_h1_21
    s_branch L_fail
L_h1ok_20:
    v_max_f32 v26, v24, v28
    s_nop 1
    v_max_f32_dpp v26, v26, v26 row_ror:8 row_mask:0xf bank_mask:0xf
    v_mov_b32 v12, v26
    s_nop 1
    v_permlane16_swap_b32 v26, v12
    v_max_f32 v26, v26, v12
    v_mov_b32 v12, v26
    s_nop 1
    v_permlane32_swap_b32 v26, v12
    v_max_f32 v26, v26, v12
    v_sub_f32 v24, v24, v26
    v_sub_f32 v28, v28, v26
    v_mul_f32 v24, s72, v24
    v_mul_f32 v28, s72, v28
    v_exp_f32 v24, v24
    v_exp_f32 v28, v28
    v_mul_f32 v40, v24, v25
    v_mul_f32 v36, v24, v16
    v_mul_f32 v37, v24, v17
    v_mul_f32 v38, v24, v18
    v_mul_f32 v39, v24, v19
    v_fmac_f32 v40, v28, v29
    v_fmac_f32 v36, v28, v20
    v_fmac_f32 v37, v28, v21
    v_fmac_f32 v38, v28, v22
    v_fmac_f32 v39, v28, v23
    v_add_f32_dpp v40, v40, v40 row_ror:8 row_mask:0xf bank_mask:0xf
    v_add_f32_dpp v36, v36, v36 row_ror:8 row_mask:0xf bank_mask:0xf
    v_add_f32_dpp v37, v37, v37 row_ror:8 row_mask:0xf bank_mask:0xf
    v_add_f32_dpp v38, v38, v38 row_ror:8 row_mask:0xf bank_mask:0xf
    v_add_f32_dpp v39, v39, v39 row_ror:8 row_mask:0xf bank_mask:0xf
    v_mov_b32 v12, v40
    v_permlane16_swap_b32 v36, v37
    v_permlane16_swap_b32 v38, v39
    v_permlane16_swap_b32 v40, v12
    v_add_f32 v36, v36, v37
    v_add_f32 v38, v38, v39
    v_add_f32 v40, v40, v12
    v_mov_b32 v12, v40
    v_permlane32_swap_b32 v36, v38
    s_nop 0
    v_permlane32_swap_b32 v40, v12
    v_add_f32 v40, v40, v12
    v_add_f32 v36, v36, v38
    v_rcp_f32 v12, v40
    s_nop 0
    v_fma_f32 v13, -v40, v12, 1.0
    v_fma_f32 v12, v13, v12, v12
    v_mul_f32 v36, v36, v12
    v_cvt_pk_bf16_f32 v36, v36, v36
    ds_write_b16 v232, v36 offset:55552
    s_mov_b32 s84, 0
    s_mov_b32 s85, -1
    s_waitcnt lgkmcnt(0)
    s_barrier
    ds_read_b128 v[48:51], v233 offset:55552
    s_waitcnt lgkmcnt(0)
    v_mfma_f32_16x16x32_bf16 v[16:19], v[48:51], v[80:83], 0
    v_mfma_f32_16x16x32_bf16 v[20:23], v[48:51], v[84:87], 0
    v_mfma_f32_16x16x32_bf16 v[24:27], v[48:51], v[88:91], 0
    v_mfma_f32_16x16x32_bf16 v[28:31], v[48:51], v[92:95], 0
    v_mfma_f32_16x16x32_bf16 v[32:35], v[48:51], v[96:99], 0
    v_mfma_f32_16x16x32_bf16 v[36:39], v[48:51], v[100:103], 0
    v_mfma_f32_16x16x32_bf16 v[40:43], v[48:51], v[104:107], 0
    v_mfma_f32_16x16x32_bf16 v[44:47], v[48:51], v[108:111], 0
    s_nop 4
    v_cndmask_b32 v52, v16, v32, s[84:85]
    v_cndmask_b32 v53, v20, v36, s[84:85]
    v_cndmask_b32 v54, v24, v40, s[84:85]
    v_cndmask_b32 v55, v28, v44, s[84:85]
    v_perm_b32 v56, v52, v196, s64
    v_perm_b32 v57, v53, v196, s65
    v_perm_b32 v58, v54, v196, s66
    v_perm_b32 v59, v55, v196, s67
    s_cmp_eq_u32 s77, 0
    s_cbranch_scc1 L_m1_22
    buffer_store_dwordx4 v[56:59], v234, s[36:39], s8 offen
    s_branch L_m2_23
L_m1_22:
    buffer_store_dwordx4 v[56:59], v234, s[36:39], s8 offen sc1
L_m2_23:
    s_branch L_ojoin_24
L_h1skip_19:
    s_barrier
L_ojoin_24:
    s_barrier
    s_cmp_lt_u32 s57, 28
    s_cbranch_scc1 L_noh1c_25
    s_mov_b32 s73, 0
L_h1c_27:
    buffer_load_dwordx4 v[16:19], v235, s[36:39], s10 offen sc1
    buffer_load_dwordx4 v[20:23], v235, s[36:39], s11 offen sc1
    buffer_load_dwordx4 v[24:27], v235, s[36:39], s12 offen sc1
    buffer_load_dwordx4 v[28:31], v235, s[36:39], s13 offen sc1
    s_waitcnt vmcnt(0)
    v_xor_b32 v16, s68, v16
    v_xor_b32 v17, s69, v17
    v_xor_b32 v18, s3, v18
    v_xor_b32 v19, s27, v19
    v_or_b32 v14, v16, v17
    v_or3_b32 v14, v14, v18, v19
    v_xor_b32 v20, s68, v20
    v_xor_b32 v21, s69, v21
    v_xor_b32 v22, s3, v22
    v_xor_b32 v23, s27, v23
    v_or3_b32 v14, v14, v20, v21
    v_or3_b32 v14, v14, v22, v23
    v_xor_b32 v24, s68, v24
    v_xor_b32 v25, s69, v25
    v_xor_b32 v26, s3, v26
    v_xor_b32 v27, s27, v27
    v_or3_b32 v14, v14, v24, v25
    v_or3_b32 v14, v14, v26, v27
    v_xor_b32 v28, s68, v28
    v_xor_b32 v29, s69, v29
    v_xor_b32 v30, s3, v30
    v_xor_b32 v31, s27, v31
    v_or3_b32 v14, v14, v28, v29
    v_or3_b32 v14, v14, v30, v31
    v_and_b32 v14, 0xff, v14
    v_cmp_ne_u32 vcc, 0, v14
    s_nop 0
    s_cmp_eq_u64 vcc, 0
    s_cbranch_scc1 L_h1cok_26
    s_add_u32 s73, s73, 1
    s_cmp_lt_u32 s73, 100000
    s_cbranch_scc1 L_h1c_27
    s_branch L_fail
L_h1cok_26:
    v_pk_add_f32 v[16:17], v[16:17], v[20:21]
    v_pk_add_f32 v[24:25], v[24:25], v[28:29]
    v_pk_add_f32 v[18:19], v[18:19], v[22:23]
    v_pk_add_f32 v[26:27], v[26:27], v[30:31]
    v_pk_add_f32 v[16:17], v[16:17], v[24:25]
    v_pk_add_f32 v[18:19], v[18:19], v[26:27]
    s_nop 0
    v_permlane16_swap_b32 v16, v17
    v_permlane16_swap_b32 v18, v19
    v_add_f32 v16, v16, v17
    v_add_f32 v18, v18, v19
    s_nop 1
    v_permlane32_swap_b32 v16, v18
    v_add_f32 v16, v16, v18
    v_perm_b32 v16, v16, v196, v237
    buffer_store_dword v16, v236, s[36:39], s26 offen sc1
L_noh1c_25:
    s_bitcmp1_b32 s56, 0
    s_cbranch_scc1 L_final
    s_cmp_lt_u32 s57, 28
    s_cbranch_scc0 L_done
    s_mov_b32 s82, s9
    s_and_b32 s83, s82, 3
    s_lshr_b32 s78, s82, 2
    s_lshl_b32 s78, s78, 7
    s_mul_i32 s79, s83, 458752
    s_add_u32 s78, s78, s79
    s_add_u32 s40, s16, s78
    s_addc_u32 s41, s17, 0
    s_mov_b32 s42, 0x0
    s_mov_b32 s43, 0x20000
    s_sub_u32 s42, 1835008, s78
    s_add_u32 s44, s18, s78
    s_addc_u32 s45, s19, 0
    s_mov_b32 s46, 0x0
    s_mov_b32 s47, 0x20000
    s_sub_u32 s46, 1835008, s78
    s_lshl_b32 s78, s82, 14
    s_add_u32 s48, s20, s78
    s_addc_u32 s49, s21, 0
    s_mov_b32 s50, 0x4000
    s_mov_b32 s51, 0x20000
    v_lshrrev_b32 v12, 3, v1
    s_lshl_b32 s78, s58, 5
    v_add_u32 v12, s78, v12
    s_movk_i32 s79, 3584
    v_mul_lo_u32 v12, v12, s79
    v_and_b32 v13, 7, v1
    v_lshl_add_u32 v12, v13, 4, v12
    s_lshl_b32 s78, s58, 12
    s_add_u32 m0, s78, 0
    s_mov_b32 s79, 0
    buffer_load_dwordx4 v12, s[40:43], s79 offen nt lds
    s_add_u32 m0, s78, 1024
    s_mov_b32 s79, 28672
    buffer_load_dwordx4 v12, s[40:43], s79 offen nt lds
    s_add_u32 m0, s78, 2048
    s_mov_b32 s79, 57344
    buffer_load_dwordx4 v12, s[40:43], s79 offen nt lds
    s_add_u32 m0, s78, 3072
    s_mov_b32 s79, 86016
    buffer_load_dwordx4 v12, s[40:43], s79 offen nt lds
    s_add_u32 m0, s78, 16384
    s_mov_b32 s79, 0
    buffer_load_dwordx4 v12, s[44:47], s79 offen nt lds
    s_add_u32 m0, s78, 17408
    s_mov_b32 s79, 28672
    buffer_load_dwordx4 v12, s[44:47], s79 offen nt lds
    s_add_u32 m0, s78, 18432
    s_mov_b32 s79, 57344
    buffer_load_dwordx4 v12, s[44:47], s79 offen nt lds
    s_add_u32 m0, s78, 19456
    s_mov_b32 s79, 86016
    buffer_load_dwordx4 v12, s[44:47], s79 offen nt lds
    v_lshrrev_b32 v13, 4, v1
    v_lshlrev_b32 v13, 12, v13
    v_and_b32 v14, 15, v1
    v_lshl_add_u32 v13, v14, 4, v13
    s_lshl_b32 s78, s58, 8
    v_add_u32 v13, s78, v13
    buffer_load_dwordx4 v[144:147], v13, s[48:51], 0 offen offset:0 nt
    buffer_load_dwordx4 v[148:151], v13, s[48:51], 0 offen offset:1024 nt
    buffer_load_dwordx4 v[152:155], v13, s[48:51], 0 offen offset:2048 nt
    buffer_load_dwordx4 v[156:159], v13, s[48:51], 0 offen offset:3072 nt
    s_and_b32 s78, s82, 0xfffffffc
    s_mul_i32 s78, s78, 3072
    s_mul_i32 s79, s83, 768
    s_add_u32 s78, s78, s79
    s_add_u32 s78, s78, 2228224
    v_lshrrev_b32 v13, 3, v1
    v_min_u32 v13, 3, v13
    v_mul_u32_u24 v13, 3072, v13
    v_and_b32 v14, 7, v1
    v_min_u32 v14, 5, v14
    v_lshl_add_u32 v13, v14, 7, v13
    buffer_load_dword v252, v13, s[36:39], s78 offen
    v_lshrrev_b32 v13, 5, v1
    v_lshlrev_b32 v13, 10, v13
    v_and_b32 v14, 31, v1
    v_lshl_add_u32 v13, v14, 3, v13
    s_lshl_b32 s78, s83, 8
    buffer_load_dwordx2 v[176:177], v13, s[52:55], s78 offen
    v_lshrrev_b32 v13, 5, v1
    v_lshlrev_b32 v13, 4, v13
    v_lshl_add_u32 v198, v14, 5, v13
    s_lshl_b32 s78, s83, 10
    v_add_u32 v198, s78, v198
    s_lshl_b32 s78, s58, 10
    v_lshl_add_u32 v203, v1, 4, s78
    v_lshlrev_b32 v204, 4, v1
    v_lshrrev_b32 v13, 4, v1
    v_bfe_u32 v14, v1, 2, 2
    v_lshl_add_u32 v14, v13, 3, v14
    v_lshlrev_b32 v14, 7, v14
    v_and_b32 v15, 3, v1
    v_lshl_add_u32 v199, v15, 3, v14
    s_lshl_b32 s78, s58, 5
    v_add_u32 v199, s78, v199
    s_lshl_b32 s78, s58, 9
    v_lshrrev_b32 v14, 5, v1
    v_lshlrev_b32 v14, 8, v14
    v_and_b32 v15, 31, v1
    v_lshl_add_u32 v201, v15, 3, v14
    v_add_u32 v201, s78, v201
    v_bfe_u32 v14, v1, 2, 1
    v_lshlrev_b32 v14, 8, v14
    v_lshl_add_u32 v200, v13, 4, v14
    v_add_u32 v200, s78, v200
    v_and_b32 v202, 15, v1
    v_lshlrev_b32 v202, 6, v202
    v_bfe_u32 v14, v1, 5, 1
    v_lshl_add_u32 v202, v14, 5, v202
    v_bfe_u32 v14, v1, 4, 1
    v_lshl_add_u32 v202, v14, 4, v202
    s_lshl_b32 s78, s58, 10
    v_add_u32 v202, s78, v202
    v_lshrrev_b32 v14, 4, v1
    v_min_u32 v14, 2, v14
    v_lshlrev_b32 v14, 8, v14
    v_and_b32 v15, 15, v1
    v_lshl_add_u32 v205, v15, 4, v14
    s_waitcnt vmcnt(0)
    s_barrier
    ds_read_b64_tr_b16 v[80:81], v199 offset:0
    ds_read_b64_tr_b16 v[82:83], v199 offset:512
    ds_read_b64_tr_b16 v[84:85], v199 offset:4096
    ds_read_b64_tr_b16 v[86:87], v199 offset:4608
    ds_read_b64_tr_b16 v[88:89], v199 offset:8192
    ds_read_b64_tr_b16 v[90:91], v199 offset:8704
    ds_read_b64_tr_b16 v[92:93], v199 offset:12288
    ds_read_b64_tr_b16 v[94:95], v199 offset:12800
    s_waitcnt lgkmcnt(4)
    ds_read_b64_tr_b16 v[96:97], v199 offset:16384
    ds_read_b64_tr_b16 v[98:99], v199 offset:16896
    ds_read_b64_tr_b16 v[100:101], v199 offset:20480
    ds_read_b64_tr_b16 v[102:103], v199 offset:20992
    ds_read_b64_tr_b16 v[104:105], v199 offset:24576
    ds_read_b64_tr_b16 v[106:107], v199 offset:25088
    ds_read_b64_tr_b16 v[108:109], v199 offset:28672
    ds_read_b64_tr_b16 v[110:111], v199 offset:29184
    v_perm_b32 v112, v148, v144, s62
    v_perm_b32 v113, v156, v152, s62
    v_perm_b32 v114, v148, v144, s63
    v_perm_b32 v115, v156, v152, s63
    v_perm_b32 v116, v149, v145, s62
    v_perm_b32 v117, v157, v153, s62
    v_perm_b32 v118, v149, v145, s63
    v_perm_b32 v119, v157, v153, s63
    v_perm_b32 v120, v150, v146, s62
    v_perm_b32 v121, v158, v154, s62
    v_perm_b32 v122, v150, v146, s63
    v_perm_b32 v123, v158, v154, s63
    v_perm_b32 v124, v151, v147, s62
    v_perm_b32 v125, v159, v155, s62
    v_perm_b32 v126, v151, v147, s63
    v_perm_b32 v127, v159, v155, s63
    v_lshlrev_b32 v178, 16, v176
    v_and_b32 v179, 0xffff0000, v176
    v_lshlrev_b32 v180, 16, v177
    v_and_b32 v181, 0xffff0000, v177
    s_lshl_b32 s80, s58, 13
    s_add_u32 s80, s80, 1179648
    s_add_u32 s81, s80, 4096
    s_waitcnt lgkmcnt(0)
    s_mov_b32 s73, 0
L_h2_29:
    buffer_load_dwordx4 v[16:19], v198, s[36:39], s80 offen sc1
    buffer_load_dwordx4 v[20:23], v198, s[36:39], s81 offen sc1
    s_waitcnt vmcnt(0)
    v_xor_b32 v16, s68, v16
    v_xor_b32 v17, s69, v17
    v_xor_b32 v18, s3, v18
    v_xor_b32 v19, s27, v19
    v_or_b32 v14, v16, v17
    v_or3_b32 v14, v14, v18, v19
    v_xor_b32 v20, s68, v20
    v_xor_b32 v21, s69, v21
    v_xor_b32 v22, s3, v22
    v_xor_b32 v23, s27, v23
    v_or3_b32 v14, v14, v20, v21
    v_or3_b32 v14, v14, v22, v23
    v_and_b32 v14, 0xff, v14
    v_cmp_ne_u32 vcc, 0, v14
    s_nop 0
    s_cmp_eq_u64 vcc, 0
    s_cbranch_scc1 L_h2ok_28
    s_add_u32 s73, s73, 1
    s_cmp_lt_u32 s73, 100000
    s_cbranch_scc1 L_h2_29
    s_branch L_fail
L_h2ok_28:
    v_pk_add_f32 v[16:17], v[16:17], v[20:21]
    v_pk_add_f32 v[18:19], v[18:19], v[22:23]
    ds_write_b128 v203, v[16:19] offset:47104
    s_waitcnt lgkmcnt(0)
    s_barrier
    ds_read_b128 v[16:19], v204 offset:47104
    ds_read_b128 v[20:23], v204 offset:48128
    ds_read_b128 v[24:27], v204 offset:49152
    ds_read_b128 v[28:31], v204 offset:50176
    s_waitcnt lgkmcnt(2)
    v_pk_add_f32 v[16:17], v[16:17], v[20:21]
    v_pk_add_f32 v[18:19], v[18:19], v[22:23]
    s_waitcnt lgkmcnt(0)
    v_pk_add_f32 v[24:25], v[24:25], v[28:29]
    v_pk_add_f32 v[26:27], v[26:27], v[30:31]
    v_pk_add_f32 v[16:17], v[16:17], v[24:25]
    v_pk_add_f32 v[18:19], v[18:19], v[26:27]
    v_cvt_pk_bf16_f32 v20, v16, v17
    v_cvt_pk_bf16_f32 v21, v18, v19
    v_lshlrev_b32 v16, 16, v20
    v_and_b32 v17, 0xffff0000, v20
    v_lshlrev_b32 v18, 16, v21
    v_and_b32 v19, 0xffff0000, v21
    v_pk_add_f32 v[24:25], v[16:17], v[178:179]
    v_pk_add_f32 v[26:27], v[18:19], v[180:181]
    v_cvt_pk_bf16_f32 v20, v24, v25
    v_cvt_pk_bf16_f32 v21, v26, v27
    ds_write_b64 v201, v[20:21] offset:56064
    v_lshlrev_b32 v24, 16, v20
    v_and_b32 v25, 0xffff0000, v20
    v_lshlrev_b32 v26, 16, v21
    v_and_b32 v27, 0xffff0000, v21
    s_waitcnt lgkmcnt(0)
    ds_read_b128 v[48:51], v200 offset:56064
    ds_read_b128 v[52:55], v200 offset:56128
    ds_read_b128 v[56:59], v200 offset:56192
    ds_read_b128 v[60:63], v200 offset:56256
    v_add_f32 v28, v24, v25
    v_mul_f32 v29, v24, v24
    v_add_f32 v18, v26, v27
    v_fmac_f32 v29, v25, v25
    v_add_f32 v28, v28, v18
    v_fmac_f32 v29, v26, v26
    v_fmac_f32 v29, v27, v27
    s_mov_b32 s84, 0xff00ff00
    s_mov_b32 s85, 0xff00ff00
    v_mov_b32 v12, 0x3f803f80
    s_waitcnt lgkmcnt(0)
    v_cndmask_b32 v48, v48, v12, s[84:85]
    v_cndmask_b32 v49, v49, v12, s[84:85]
    v_cndmask_b32 v50, v50, v12, s[84:85]
    v_cndmask_b32 v51, v51, v12, s[84:85]
    v_cndmask_b32 v52, v52, v12, s[84:85]
    v_cndmask_b32 v53, v53, v12, s[84:85]
    v_cndmask_b32 v54, v54, v12, s[84:85]
    v_cndmask_b32 v55, v55, v12, s[84:85]
    v_cndmask_b32 v56, v56, v12, s[84:85]
    v_cndmask_b32 v57, v57, v12, s[84:85]
    v_cndmask_b32 v58, v58, v12, s[84:85]
    v_cndmask_b32 v59, v59, v12, s[84:85]
    v_cndmask_b32 v60, v60, v12, s[84:85]
    v_cndmask_b32 v61, v61, v12, s[84:85]
    v_cndmask_b32 v62, v62, v12, s[84:85]
    v_cndmask_b32 v63, v63, v12, s[84:85]
    v_mfma_f32_16x16x32_bf16 v[16:19], v[48:51], v[80:83], 0
    v_mfma_f32_16x16x32_bf16 v[20:23], v[48:51], v[96:99], 0
    v_mfma_f32_16x16x32_bf16 v[16:19], v[52:55], v[84:87], v[16:19]
    v_mfma_f32_16x16x32_bf16 v[20:23], v[52:55], v[100:103], v[20:23]
    v_mfma_f32_16x16x32_bf16 v[16:19], v[56:59], v[88:91], v[16:19]
    v_mfma_f32_16x16x32_bf16 v[20:23], v[56:59], v[104:107], v[20:23]
    v_mfma_f32_16x16x32_bf16 v[16:19], v[60:63], v[92:95], v[16:19]
    v_mfma_f32_16x16x32_bf16 v[20:23], v[60:63], v[108:111], v[20:23]
    v_add_f32_dpp v28, v28, v28 row_ror:8 row_mask:0xf bank_mask:0xf
    v_add_f32_dpp v29, v29, v29 row_ror:8 row_mask:0xf bank_mask:0xf
    s_nop 0
    v_add_f32_dpp v28, v28, v28 row_ror:4 row_mask:0xf bank_mask:0xf
    v_add_f32_dpp v29, v29, v29 row_ror:4 row_mask:0xf bank_mask:0xf
    s_nop 0
    v_add_f32_dpp v28, v28, v28 row_ror:2 row_mask:0xf bank_mask:0xf
    v_add_f32_dpp v29, v29, v29 row_ror:2 row_mask:0xf bank_mask:0xf
    s_nop 0
    v_add_f32_dpp v28, v28, v28 row_ror:1 row_mask:0xf bank_mask:0xf
    v_add_f32_dpp v29, v29, v29 row_ror:1 row_mask:0xf bank_mask:0xf
    v_mov_b32 v13, v28
    v_mov_b32 v14, v29
    s_nop 0
    v_permlane16_swap_b32 v28, v13
    v_permlane16_swap_b32 v29, v14
    v_add_f32 v28, v28, v13
    v_add_f32 v29, v29, v14
    v_mov_b32 v13, v28
    v_mov_b32 v14, v29
    s_nop 0
    v_permlane32_swap_b32 v28, v13
    v_permlane32_swap_b32 v29, v14
    s_mov_b32 s84, 0xffff0000
    s_mov_b32 s85, 0
    v_cndmask_b32 v50, v28, v13, s[84:85]
    v_cndmask_b32 v51, v29, v14, s[84:85]
    v_perm_b32 v52, v16, v196, s64
    v_perm_b32 v53, v20, v196, s65
    v_perm_b32 v54, v50, v196, s66
    v_perm_b32 v55, v51, v196, s67
    s_mul_i32 s78, s82, 3072
    s_mul_i32 s79, s58, 768
    s_add_u32 s78, s78, s79
    s_add_u32 s78, s78, 2228224
    s_mov_b32 exec_hi, 0xffff
    s_cmp_eq_u32 s77, 0
    s_cbranch_scc1 L_m1_30
    buffer_store_dwordx4 v[52:55], v204, s[36:39], s78 offen
    s_branch L_m2_31
L_m1_30:
    buffer_store_dwordx4 v[52:55], v204, s[36:39], s78 offen sc1
L_m2_31:
    s_mov_b64 exec, -1
    s_and_b32 s78, s82, 0xfffffffc
    s_mul_i32 s78, s78, 3072
    s_mul_i32 s79, s83, 768
    s_add_u32 s78, s78, s79
    s_add_u32 s78, s78, 2228224
    s_add_u32 s79, s78, 3072
    s_add_u32 s80, s78, 6144
    s_add_u32 s81, s78, 9216
    s_mov_b32 s73, 0
L_hf_33:
    buffer_load_dwordx4 v[16:19], v205, s[36:39], s78 offen sc1
    buffer_load_dwordx4 v[20:23], v205, s[36:39], s79 offen sc1
    buffer_load_dwordx4 v[24:27], v205, s[36:39], s80 offen sc1
    buffer_load_dwordx4 v[28:31], v205, s[36:39], s81 offen sc1
    s_waitcnt vmcnt(0)
    v_xor_b32 v16, s68, v16
    v_xor_b32 v17, s69, v17
    v_xor_b32 v18, s3, v18
    v_xor_b32 v19, s27, v19
    v_or_b32 v14, v16, v17
    v_or3_b32 v14, v14, v18, v19
    v_xor_b32 v20, s68, v20
    v_xor_b32 v21, s69, v21
    v_xor_b32 v22, s3, v22
    v_xor_b32 v23, s27, v23
    v_or3_b32 v14, v14, v20, v21
    v_or3_b32 v14, v14, v22, v23
    v_xor_b32 v24, s68, v24
    v_xor_b32 v25, s69, v25
    v_xor_b32 v26, s3, v26
    v_xor_b32 v27, s27, v27
    v_or3_b32 v14, v14, v24, v25
    v_or3_b32 v14, v14, v26, v27
    v_xor_b32 v28, s68, v28
    v_xor_b32 v29, s69, v29
    v_xor_b32 v30, s3, v30
    v_xor_b32 v31, s27, v31
    v_or3_b32 v14, v14, v28, v29
    v_or3_b32 v14, v14, v30, v31
    v_and_b32 v14, 0xff, v14
    v_cmp_ne_u32 vcc, 0, v14
    s_nop 0
    s_cmp_eq_u64 vcc, 0
    s_cbranch_scc1 L_hfok_32
    s_add_u32 s73, s73, 1
    s_cmp_lt_u32 s73, 100000
    s_cbranch_scc1 L_hf_33
    s_branch L_fail
L_hfok_32:
    v_pk_add_f32 v[16:17], v[16:17], v[20:21]
    v_pk_add_f32 v[24:25], v[24:25], v[28:29]
    v_pk_add_f32 v[18:19], v[18:19], v[22:23]
    v_pk_add_f32 v[26:27], v[26:27], v[30:31]
    v_pk_add_f32 v[16:17], v[16:17], v[24:25]
    v_pk_add_f32 v[18:19], v[18:19], v[26:27]
    v_mov_b32 v12, v16
    v_mov_b32 v13, v17
    s_nop 0
    v_permlane32_swap_b32 v12, v20
    v_permlane32_swap_b32 v13, v21
    v_mul_f32 v22, 0x3b000000, v18
    v_mul_f32 v23, 0x3b000000, v19
    v_fma_f32 v23, -v22, v22, v23
    v_cvt_pk_bf16_f32 v12, v22, v23
    v_lshlrev_b32 v22, 16, v12
    v_and_b32 v23, 0xffff0000, v12
    v_add_f32 v23, 0x3727c5ac, v23
    v_cvt_pk_bf16_f32 v23, v23, v23
    v_lshlrev_b32 v23, 16, v23
    v_sqrt_f32 v23, v23
    v_fma_f32 v16, -v22, v20, v16
    v_fma_f32 v17, -v22, v21, v17
    v_cvt_pk_bf16_f32 v23, v23, v23
    v_lshlrev_b32 v23, 16, v23
    v_rcp_f32 v23, v23
    s_nop 0
    v_mul_f32 v16, v16, v23
    v_mul_f32 v17, v17, v23
    v_cvt_pk_bf16_f32 v12, v16, v17
    v_lshlrev_b32 v16, 16, v12
    v_and_b32 v17, 0xffff0000, v12
    v_mul_f32 v12, s72, v16
    v_exp_f32 v12, -v12
    s_nop 0
    v_add_f32 v12, 1.0, v12
    v_rcp_f32 v12, v12
    s_nop 0
    v_mul_f32 v16, v16, v12
    v_cvt_pk_bf16_f32 v12, v16, v16
    v_lshlrev_b32 v16, 16, v12
    v_mul_f32 v16, v16, v17
    v_cvt_pk_bf16_f32 v16, v16, v16
    s_lshl_b32 s78, s58, 6
    v_lshl_add_u32 v12, v1, 1, s78
    s_mov_b32 exec_hi, 0
    ds_write_b16 v12, v16 offset:58368
    s_mov_b64 exec, -1
    v_bfe_u32 v12, v1, 2, 1
    v_lshlrev_b32 v12, 5, v12
    v_lshrrev_b32 v13, 4, v1
    v_lshl_add_u32 v12, v13, 3, v12
    v_add_u32 v12, s78, v12
    s_waitcnt lgkmcnt(0)
    ds_read_b64 v[48:49], v12 offset:58368
    s_mov_b32 s84, 0
    s_mov_b32 s85, -1
    s_lshl_b32 s78, s82, 12
    s_add_u32 s78, s78, 1245184
    s_waitcnt lgkmcnt(0)
    v_mfma_f32_16x16x16_bf16 v[16:19], v[48:49], v[112:113], 0
    v_mfma_f32_16x16x16_bf16 v[20:23], v[48:49], v[114:115], 0
    v_mfma_f32_16x16x16_bf16 v[24:27], v[48:49], v[116:117], 0
    v_mfma_f32_16x16x16_bf16 v[28:31], v[48:49], v[118:119], 0
    v_mfma_f32_16x16x16_bf16 v[32:35], v[48:49], v[120:121], 0
    v_mfma_f32_16x16x16_bf16 v[36:39], v[48:49], v[122:123], 0
    v_mfma_f32_16x16x16_bf16 v[40:43], v[48:49], v[124:125], 0
    v_mfma_f32_16x16x16_bf16 v[44:47], v[48:49], v[126:127], 0
    s_nop 4
    v_cndmask_b32 v52, v16, v32, s[84:85]
    v_cndmask_b32 v53, v20, v36, s[84:85]
    v_cndmask_b32 v54, v24, v40, s[84:85]
    v_cndmask_b32 v55, v28, v44, s[84:85]
    v_perm_b32 v56, v52, v196, s64
    v_perm_b32 v57, v53, v196, s65
    v_perm_b32 v58, v54, v196, s66
    v_perm_b32 v59, v55, v196, s67
    buffer_store_dwordx4 v[56:59], v202, s[36:39], s78 offen sc1
    s_branch L_done
L_final:
    s_cmp_lg_u32 s58, 0
    s_cbranch_scc1 L_done
    v_and_b32 v12, 1, v1
    v_lshlrev_b32 v178, 10, v12
    s_lshl_b32 s78, s9, 3
    buffer_load_dwordx2 v[176:177], v178, s[52:55], s78 offen
    v_bfe_u32 v13, v1, 1, 3
    v_lshlrev_b32 v13, 12, v13
    v_lshl_add_u32 v179, v12, 4, v13
    v_lshrrev_b32 v13, 1, v1
    v_lshlrev_b32 v13, 12, v13
    v_lshl_add_u32 v180, v12, 4, v13
    s_mov_b32 s84, 0
    s_mov_b32 s85, -1
    v_add_u32 v181, 393216, v180
    v_subrev_u32 v13, 65536, v180
    v_cndmask_b32 v181, v181, v13, s[84:85]
    s_lshl_b32 s78, s9, 5
    s_add_u32 s4, s78, 1179648
    s_add_u32 s5, s78, 1245184
    s_add_u32 s6, s5, 131072
    s_add_u32 s7, s5, 262144
    s_mov_b32 s44, s22
    s_mov_b32 s45, s23
    s_mov_b32 s46, 0x800
    s_mov_b32 s47, 0x20000
    s_lshl_b32 s8, s9, 3
    s_mov_b32 s73, 0
L_hy_35:
    buffer_load_dwordx4 v[20:23], v179, s[36:39], s4 offen sc1
    s_waitcnt vmcnt(0)
    v_xor_b32 v20, s68, v20
    v_xor_b32 v21, s69, v21
    v_xor_b32 v22, s3, v22
    v_xor_b32 v23, s27, v23
    v_or_b32 v14, v20, v21
    v_or3_b32 v14, v14, v22, v23
    v_and_b32 v14, 0xff, v14
    v_cmp_ne_u32 vcc, 0, v14
    s_nop 0
    s_cmp_eq_u64 vcc, 0
    s_cbranch_scc1 L_hyok_34
    s_add_u32 s73, s73, 1
    s_cmp_lt_u32 s73, 100000
    s_cbranch_scc1 L_hy_35
    s_branch L_fail
L_hyok_34:
    v_add_f32_dpp v20, v20, v20 row_ror:8 row_mask:0xf bank_mask:0xf
    v_add_f32_dpp v21, v21, v21 row_ror:8 row_mask:0xf bank_mask:0xf
    v_add_f32_dpp v22, v22, v22 row_ror:8 row_mask:0xf bank_mask:0xf
    v_add_f32_dpp v23, v23, v23 row_ror:8 row_mask:0xf bank_mask:0xf
    v_add_f32_dpp v20, v20, v20 row_ror:4 row_mask:0xf bank_mask:0xf
    v_add_f32_dpp v21, v21, v21 row_ror:4 row_mask:0xf bank_mask:0xf
    v_add_f32_dpp v22, v22, v22 row_ror:4 row_mask:0xf bank_mask:0xf
    v_add_f32_dpp v23, v23, v23 row_ror:4 row_mask:0xf bank_mask:0xf
    v_add_f32_dpp v20, v20, v20 row_ror:2 row_mask:0xf bank_mask:0xf
    v_add_f32_dpp v21, v21, v21 row_ror:2 row_mask:0xf bank_mask:0xf
    v_add_f32_dpp v22, v22, v22 row_ror:2 row_mask:0xf bank_mask:0xf
    v_add_f32_dpp v23, v23, v23 row_ror:2 row_mask:0xf bank_mask:0xf
    v_cvt_pk_bf16_f32 v24, v20, v21
    v_cvt_pk_bf16_f32 v25, v22, v23
    v_lshlrev_b32 v20, 16, v24
    v_and_b32 v21, 0xffff0000, v24
    v_lshlrev_b32 v28, 16, v176
    v_and_b32 v29, 0xffff0000, v176
    v_lshlrev_b32 v22, 16, v25
    v_and_b32 v23, 0xffff0000, v25
    v_lshlrev_b32 v30, 16, v177
    v_and_b32 v31, 0xffff0000, v177
    v_add_f32 v28, v28, v20
    v_add_f32 v29, v29, v21
    v_add_f32 v30, v30, v22
    v_add_f32 v31, v31, v23
    v_cvt_pk_bf16_f32 v24, v28, v29
    v_cvt_pk_bf16_f32 v25, v30, v31
    v_lshlrev_b32 v28, 16, v24
    v_and_b32 v29, 0xffff0000, v24
    v_lshlrev_b32 v30, 16, v25
    v_and_b32 v31, 0xffff0000, v25
    v_lshrrev_b32 v12, 4, v1
    v_cmp_eq_u32 vcc, 1, v12
    s_nop 1
    v_cndmask_b32 v26, v28, v29, vcc
    v_cmp_eq_u32 vcc, 2, v12
    s_nop 1
    v_cndmask_b32 v26, v26, v30, vcc
    v_cmp_eq_u32 vcc, 3, v12
    s_nop 1
    v_cndmask_b32 v26, v26, v31, vcc
    v_lshl_add_u32 v27, v12, 1, v178
    s_mov_b32 s73, 0
L_h3_37:
    buffer_load_dwordx4 v[32:35], v180, s[36:39], s5 offen sc1
    buffer_load_dwordx4 v[36:39], v180, s[36:39], s6 offen sc1
    buffer_load_dwordx4 v[40:43], v180, s[36:39], s7 offen sc1
    buffer_load_dwordx4 v[44:47], v181, s[36:39], s5 offen sc1
    s_waitcnt vmcnt(0)
    v_xor_b32 v32, s68, v32
    v_xor_b32 v33, s69, v33
    v_xor_b32 v34, s3, v34
    v_xor_b32 v35, s27, v35
    v_or_b32 v14, v32, v33
    v_or3_b32 v14, v14, v34, v35
    v_xor_b32 v36, s68, v36
    v_xor_b32 v37, s69, v37
    v_xor_b32 v38, s3, v38
    v_xor_b32 v39, s27, v39
    v_or3_b32 v14, v14, v36, v37
    v_or3_b32 v14, v14, v38, v39
    v_xor_b32 v40, s68, v40
    v_xor_b32 v41, s69, v41
    v_xor_b32 v42, s3, v42
    v_xor_b32 v43, s27, v43
    v_or3_b32 v14, v14, v40, v41
    v_or3_b32 v14, v14, v42, v43
    v_xor_b32 v44, s68, v44
    v_xor_b32 v45, s69, v45
    v_xor_b32 v46, s3, v46
    v_xor_b32 v47, s27, v47
    v_or3_b32 v14, v14, v44, v45
    v_or3_b32 v14, v14, v46, v47
    v_and_b32 v14, 0xff, v14
    v_cmp_ne_u32 vcc, 0, v14
    s_nop 0
    s_cmp_eq_u64 vcc, 0
    s_cbranch_scc1 L_h3ok_36
    s_add_u32 s73, s73, 1
    s_cmp_lt_u32 s73, 100000
    s_cbranch_scc1 L_h3_37
    s_branch L_fail
L_h3ok_36:
    v_cndmask_b32 v44, v44, 0, s[84:85]
    v_cndmask_b32 v45, v45, 0, s[84:85]
    v_cndmask_b32 v46, v46, 0, s[84:85]
    v_cndmask_b32 v47, v47, 0, s[84:85]
    v_pk_add_f32 v[32:33], v[32:33], v[36:37]
    v_pk_add_f32 v[40:41], v[40:41], v[44:45]
    v_pk_add_f32 v[34:35], v[34:35], v[38:39]
    v_pk_add_f32 v[42:43], v[42:43], v[46:47]
    v_pk_add_f32 v[32:33], v[32:33], v[40:41]
    v_pk_add_f32 v[34:35], v[34:35], v[42:43]
    s_nop 0
    v_permlane16_swap_b32 v32, v33
    v_permlane16_swap_b32 v34, v35
    v_add_f32 v32, v32, v33
    v_add_f32 v34, v34, v35
    s_nop 1
    v_permlane32_swap_b32 v32, v34
    v_add_f32 v32, v32, v34
    s_nop 1
    v_add_f32_dpp v32, v32, v32 row_ror:8 row_mask:0xf bank_mask:0xf
    s_nop 1
    v_add_f32_dpp v32, v32, v32 row_ror:4 row_mask:0xf bank_mask:0xf
    s_nop 1
    v_add_f32_dpp v32, v32, v32 row_ror:2 row_mask:0xf bank_mask:0xf
    v_mov_b32 v33, v26
    v_cvt_pk_bf16_f32 v32, v32, v32
    v_lshlrev_b32 v32, 16, v32
    v_add_f32 v32, v32, v33
    v_cvt_pk_bf16_f32 v32, v32, v32
    s_mov_b32 exec_lo, 0x00030003
    s_mov_b32 exec_hi, 0x00030003
    buffer_store_short v32, v27, s[44:47], s8 offen
    s_cmp_lg_u32 s9, 0
    s_cbranch_scc1 L_done
    s_mov_b64 exec, 1
    v_mov_b32 v12, s86
    v_mov_b32 v13, 0
    buffer_store_dword v12, v13, s[36:39], 0 offen offset:0
    s_branch L_done
L_fail:
L_done:
    s_mov_b64 exec, -1
    s_waitcnt vmcnt(0)
L_end:
    s_endpgm
.section .rodata,"a"
.p2align 6
.amdhsa_kernel sequential_preLN__gqa_block_cached__swiglu_ffn__decode_kernel
  .amdhsa_next_free_vgpr 512
  .amdhsa_next_free_sgpr 102
  .amdhsa_accum_offset 256
  .amdhsa_group_segment_fixed_size 0
  .amdhsa_kernarg_size 96
  .amdhsa_user_sgpr_count 2
  .amdhsa_user_sgpr_kernarg_segment_ptr 1
  .amdhsa_system_sgpr_workgroup_id_x 1
.end_amdhsa_kernel
```
